```python
import torch

def _softmax(x, axis=-1):
    return torch.softmax(x, dim=axis)
def _gelu(x):
    return torch.nn.functional.gelu(x, approximate="tanh")
def _silu(x):
    return torch.nn.functional.silu(x)
def _sigmoid(x):
    return torch.sigmoid(x)
def _layernorm(x, axis=-1, eps=1e-5):
    m = x.mean(dim=axis, keepdim=True)
    v = x.var(dim=axis, keepdim=True, unbiased=False)
    return (x - m) / torch.sqrt(v + eps)
def _scatter_add(tgt, idx, src, axis=0):
    return tgt.clone().index_add_(axis, idx, src)
def _segment_sum(src, seg, n):
    out = torch.zeros((n,) + src.shape[1:], dtype=src.dtype)
    return out.index_add_(0, seg, src)
def _pad(x, pw):
    flat = tuple(v for pair in reversed(pw) for v in pair)
    return torch.nn.functional.pad(x, flat)

kernel_name = 'sequential_preLN__ssm_conv_h3__swiglu_ffn__prompt'

def setup_inputs():

    _w = (lambda a: (lambda t: t.to(torch.bfloat16) if t.is_floating_point() else t)(torch.as_tensor(a)))
    def _A_setup():
        B, S, D = 1, 2048, 512
        ks = 4
        return {
            "q": _w((lambda *s: torch.randn(*s, dtype=torch.bfloat16) * 0.05)(B, S, D)),
            "k": _w((lambda *s: torch.randn(*s, dtype=torch.bfloat16) * 0.4)(B, S, D)),
            "v": _w((lambda *s: torch.randn(*s, dtype=torch.bfloat16) * 0.4)(B, S, D)),
            "shift_k": _w((lambda *s: torch.randn(*s, dtype=torch.bfloat16) * 0.4)(D, ks) * 0.5),
            "ssm_k": _w((lambda *s: torch.randn(*s, dtype=torch.bfloat16) * 0.4)(D, S) * (1.0 / S ** 0.5)),
            "ssm_D": _w((lambda *s: torch.randn(*s, dtype=torch.bfloat16) * 0.4)(D)),
        }
    _A_in = _A_setup()

    def _B_setup():
        B, S, D, F = 1, 2048, 512, 1792
        return {
            "x": _w((lambda *s: torch.randn(*s, dtype=torch.bfloat16) * 0.05)(B, S, D)),
            "w_gate": _w((lambda *s: torch.randn(*s, dtype=torch.bfloat16) * 0.05)(D, F)),
            "w_up": _w((lambda *s: torch.randn(*s, dtype=torch.bfloat16) * 0.05)(D, F)),
            "w_down": _w((lambda *s: torch.randn(*s, dtype=torch.bfloat16) * 0.05)(F, D)),
        }
    _B_in = _B_setup()

    return {
        "A_q": _A_in["q"],
        "A_k": _A_in["k"],
        "A_v": _A_in["v"],
        "A_shift_k": _A_in["shift_k"],
        "A_ssm_k": _A_in["ssm_k"],
        "A_ssm_D": _A_in["ssm_D"],
        "B_x": _B_in["x"],
        "B_w_gate": _B_in["w_gate"],
        "B_w_up": _B_in["w_up"],
        "B_w_down": _B_in["w_down"],
    }

def reference(A_q, A_k, A_v, A_shift_k, A_ssm_k, A_ssm_D, B_x, B_w_gate, B_w_up, B_w_down):
    def _A_ref(q, k, v, shift_k, ssm_k, ssm_D):
        B, S, D = q.shape
        ks = shift_k.shape[-1]
        k_pad = _pad(k, ((0, 0), (ks - 1, 0), (0, 0)))
        k_shift = torch.zeros_like(k)
        for t in range(ks):
            k_shift = k_shift + k_pad[:, t:t + S, :] * shift_k[:, ks - 1 - t][None, None, :]
        kv = k_shift * v
        L = 2 * S
        kv_pad = _pad(kv, ((0, 0), (0, S), (0, 0)))
        kf_pad = _pad(ssm_k, ((0, 0), (0, S)))
        kv_f = (lambda x, axes=(-2,-1): torch.fft.rfft2(x.float(), dim=axes))(kv_pad[:, None, :, :], axes=(1, 2))
        kf_f = (lambda x, axes=(-2,-1): torch.fft.rfft2(x.float(), dim=axes))(kf_pad[:, None, :], axes=(1, 2))
        kf_f = (lambda x, *d: x.permute(*d))(kf_f, 1, 2, 0)
        y_f = kv_f * kf_f[None, :, :, :]
        y = (lambda x, s, axes=(-2,-1): torch.fft.irfft2(x, s=s, dim=axes).to(torch.bfloat16))(y_f, (1, L), axes=(1, 2))[:, 0, :S, :]
        y = y + kv * ssm_D[None, None, :]
        return q * y

    def _B_ref(x, w_gate, w_up, w_down):
        g = _silu(x @ w_gate)
        u = x @ w_up
        return (g * u) @ w_down

    x = A_q
    h = x + _A_ref(_layernorm(x, axis=-1), A_k, A_v, A_shift_k, A_ssm_k, A_ssm_D)
    h2 = h + _B_ref(_layernorm(h, axis=-1), B_w_gate, B_w_up, B_w_down)
    return h2
```

```asm
; @launch grid=(256,1,1) block=(512,1,1) lds=163840
.amdgcn_target "amdgcn-amd-amdhsa--gfx950"
.text
.globl sequential_preLN__ssm_conv_h3__swiglu_ffn__prompt_kernel
.p2align 8
.type sequential_preLN__ssm_conv_h3__swiglu_ffn__prompt_kernel,@function
sequential_preLN__ssm_conv_h3__swiglu_ffn__prompt_kernel:
    s_cmp_ge_u32 s2, 256
    s_cbranch_scc1 L_end
    s_load_dwordx2 s[48:49], s[0:1], 8
    s_load_dwordx2 s[52:53], s[0:1], 16
    s_load_dwordx2 s[44:45], s[0:1], 0
    s_load_dwordx2 s[56:57], s[0:1], 24
    s_load_dwordx2 s[84:85], s[0:1], 96
    s_load_dwordx2 s[60:61], s[0:1], 32
    s_load_dwordx2 s[80:81], s[0:1], 88
    s_mov_b32 s46, 0x200000
    s_mov_b32 s47, 0x20000
    s_mov_b32 s50, 0x200000
    s_mov_b32 s51, 0x20000
    s_mov_b32 s54, 0x200000
    s_mov_b32 s55, 0x20000
    s_mov_b32 s58, 0x1000
    s_mov_b32 s59, 0x20000
    s_mov_b32 s62, 0x200000
    s_mov_b32 s63, 0x20000
    s_mov_b32 s66, 0x1c0000
    s_mov_b32 s67, 0x20000
    s_mov_b32 s70, 0x1c0000
    s_mov_b32 s71, 0x20000
    s_mov_b32 s74, 0x1c0000
    s_mov_b32 s75, 0x20000
    s_mov_b32 s78, 0x200000
    s_mov_b32 s79, 0x20000
    s_mov_b32 s82, 0x100
    s_mov_b32 s83, 0x20000
    s_mov_b32 s86, 0x1400000
    s_mov_b32 s87, 0x20000
    v_lshrrev_b32 v2, 6, v0
    v_and_b32 v1, 63, v0
    v_readfirstlane_b32 s99, v2
    v_and_b32 v0, 255, v0
    s_and_b32 s4, s2, 7
    s_lshr_b32 s5, s2, 3
    s_and_b32 s11, s5, 7
    s_lshr_b32 s12, s5, 3
    s_lshl_b32 s12, s12, 3
    s_add_u32 s12, s12, s4
    s_lshl_b32 s10, s11, 5
    s_add_u32 s10, s10, s12
    s_lshr_b32 s6, s4, 1
    s_lshl_b32 s6, s6, 2
    s_and_b32 s13, s5, 3
    s_add_u32 s6, s6, s13
    s_and_b32 s8, s4, 1
    s_lshr_b32 s9, s5, 2
    s_lshl_b32 s7, s8, 3
    s_add_u32 s7, s7, s9
    s_and_b32 s3, s99, 3
    v_lshlrev_b32 v7, 4, v1
    v_mov_b32 v8, 0
    v_mov_b32 v10, 0x80000000
    v_and_b32 v5, 7, v0
    v_lshrrev_b32 v4, 3, v0
    v_lshrrev_b32 v2, 3, v1
    v_lshlrev_b32 v2, 10, v2
    v_lshl_add_u32 v2, v5, 4, v2
    s_lshl_b32 s13, s12, 16
    s_lshl_b32 s14, s11, 7
    s_add_u32 s13, s13, s14
    v_add_u32 v3, s13, v2
    s_lshl_b32 s14, s3, 14
    s_add_u32 s15, s14, 8192
    s_mul_i32 s90, s3, 2080
    s_mov_b32 s93, 0xffff0000
    s_mov_b32 s16, 1
    v_lshlrev_b32 v6, 13, v4
    v_lshl_add_u32 v6, v5, 4, v6
    s_lshl_b32 s13, s11, 18
    s_lshl_b32 s91, s12, 7
    s_add_u32 s13, s13, s91
    v_add_u32 v6, s13, v6
    v_mul_u32_u24 v9, 1040, v5
    v_lshl_add_u32 v9, v4, 2, v9
    s_waitcnt lgkmcnt(0)
    s_cmp_ge_u32 s99, 4
    s_cbranch_scc1 L_pathB
    s_add_u32 m0, s90, 99344
    s_nop 0
    buffer_load_dwordx4 v3, s[48:51], s14 offen lds
    s_add_u32 m0, s90, 100384
    s_nop 0
    buffer_load_dwordx4 v3, s[48:51], s15 offen lds
    s_add_u32 m0, s90, 107664
    s_nop 0
    buffer_load_dwordx4 v3, s[52:55], s14 offen lds
    s_add_u32 m0, s90, 108704
    s_nop 0
    buffer_load_dwordx4 v3, s[52:55], s15 offen lds
    v_subrev_u32 v11, 8192, v3
    s_cmp_lg_u32 s3, 3
    s_cbranch_scc1 L_nohalo
    s_mov_b32 m0, 98304
    s_nop 0
    buffer_load_dwordx4 v11, s[48:51], 0 offen lds
L_nohalo:
    s_lshl_b32 s13, s11, 9
    v_lshl_add_u32 v11, v4, 4, s13
    buffer_load_dwordx4 v[44:47], v11, s[56:59], 0 offen
    s_lshl_b32 s13, s10, 13
    v_lshl_add_u32 v28, v0, 5, s13
    v_subrev_u32 v29, 8, v28
    v_and_b32 v30, 127, v0
    v_cmp_eq_u32 vcc, 0, v30
    s_nop 1
    v_cndmask_b32 v29, v29, v10, vcc
    v_mov_b32 v32, 0
    v_mov_b32 v33, 0
    v_mov_b32 v34, 0
    v_mov_b32 v35, 0
    v_bfe_u32 v31, v0, 1, 3
    v_mul_u32_u24 v31, 4160, v31
    v_and_b32 v27, 1, v0
    v_lshl_add_u32 v31, v27, 4, v31
    v_add_u32 v31, 130560, v31
    v_lshlrev_b32 v27, 4, v27
    v_add_u32 v27, 125184, v27
    v_cmp_gt_u32 vcc, 16, v0
    s_nop 1
    v_cndmask_b32 v31, v27, v31, vcc
    ds_write_b128 v31, v[32:35]
    s_waitcnt lgkmcnt(0)
    s_barrier
    s_load_dwordx2 s[72:73], s[0:1], 72
    s_load_dwordx2 s[64:65], s[0:1], 56
    s_load_dwordx2 s[68:69], s[0:1], 64
    s_load_dwordx2 s[76:77], s[0:1], 80
    s_load_dwordx2 s[88:89], s[0:1], 40
    v_add_u32 v12, 98304, v9
    v_add_u32 v13, 99344, v9
    v_add_u32 v14, 107664, v9
    v_and_b32 v20, 15, v1
    v_lshrrev_b32 v21, 4, v1
    v_sub_u32 v22, 3, v20
    v_and_b32 v22, 3, v22
    v_add3_u32 v15, v20, v22, 1
    v_lshl_add_u32 v15, v21, 3, v15
    v_lshlrev_b32 v15, 1, v15
    v_mul_u32_u24 v22, 4160, v22
    v_add_u32 v15, v15, v22
    s_lshr_b32 s96, s3, 1
    s_and_b32 s97, s3, 1
    s_mul_i32 s13, s96, 16640
    s_lshl_b32 s94, s97, 8
    s_add_u32 s13, s13, s94
    s_add_u32 s13, s13, 130560
    v_add_u32 v15, s13, v15
    v_lshlrev_b32 v16, 1, v20
    v_sub_u32 v16, v16, v21
    v_lshlrev_b32 v16, 4, v16
    s_mul_i32 s95, s3, 4608
    s_add_u32 s95, s95, 98304
    s_sub_u32 s13, s95, s94
    s_add_u32 s13, s13, 336
    v_add_u32 v16, s13, v16
    s_lshl_b32 s92, s10, 13
    s_lshl_b32 s14, s96, 12
    s_add_u32 s92, s92, s14
    s_lshl_b32 s13, s3, 13
    s_add_u32 s13, s13, 131072
    v_add_u32 v17, s13, v7
    s_movk_i32 s15, 4096
    s_waitcnt vmcnt(0)
    s_waitcnt lgkmcnt(0)
    v_mov_b32 v18, 1
    v_mov_b32 v19, 125212
    s_mov_b64 exec, 1
    ds_add_u32 v19, v18
    s_mov_b64 exec, -1
    s_mov_b32 s98, 0
    v_mov_b32 v19, 125212
L_spin_1:
    ds_read_b32 v18, v19
    s_add_u32 s98, s98, 1
    s_waitcnt lgkmcnt(0)
    v_cmp_ne_u32 vcc, 4, v18
    s_cbranch_vccz L_sdone_2
    s_cmp_lt_u32 s98, 0x1000000
    s_cbranch_scc1 L_spin_1
L_sdone_2:
    ds_read2_b32 v[48:49], v12 offset0:128 offset1:160
    ds_read2_b32 v[50:51], v12 offset0:192 offset1:224
    ds_read2_b32 v[52:53], v13 offset0:0 offset1:32
    ds_read2_b32 v[54:55], v13 offset0:64 offset1:96
    ds_read2_b32 v[56:57], v13 offset0:128 offset1:160
    ds_read2_b32 v[58:59], v13 offset0:192 offset1:224
    ds_read2_b32 v[60:61], v14 offset0:0 offset1:32
    ds_read2_b32 v[62:63], v14 offset0:64 offset1:96
    ds_read2_b32 v[64:65], v14 offset0:128 offset1:160
    ds_read2_b32 v[66:67], v14 offset0:192 offset1:224
    v_lshlrev_b32 v102, 16, v44
    v_lshlrev_b32 v103, 16, v46
    v_and_b32 v104, s93, v44
    v_and_b32 v105, s93, v46
    v_lshlrev_b32 v106, 16, v45
    v_lshlrev_b32 v107, 16, v47
    v_and_b32 v108, s93, v45
    v_and_b32 v109, s93, v47
    s_waitcnt lgkmcnt(4)
    v_lshlrev_b32 v80, 16, v49
    v_and_b32 v81, s93, v49
    v_lshlrev_b32 v82, 16, v50
    v_and_b32 v83, s93, v50
    v_lshlrev_b32 v84, 16, v51
    v_and_b32 v85, s93, v51
    v_lshlrev_b32 v86, 16, v52
    v_and_b32 v87, s93, v52
    v_lshlrev_b32 v88, 16, v53
    v_and_b32 v89, s93, v53
    v_lshlrev_b32 v90, 16, v54
    v_and_b32 v91, s93, v54
    v_lshlrev_b32 v92, 16, v55
    v_and_b32 v93, s93, v55
    v_lshlrev_b32 v94, 16, v56
    v_and_b32 v95, s93, v56
    v_lshlrev_b32 v96, 16, v57
    v_and_b32 v97, s93, v57
    v_lshlrev_b32 v98, 16, v58
    v_and_b32 v99, s93, v58
    v_lshlrev_b32 v100, 16, v59
    v_and_b32 v101, s93, v59
    v_pk_mul_f32 v[110:111], v[108:109], v[80:81]
    v_pk_mul_f32 v[112:113], v[108:109], v[82:83]
    v_pk_mul_f32 v[114:115], v[108:109], v[84:85]
    v_pk_mul_f32 v[116:117], v[108:109], v[86:87]
    v_pk_mul_f32 v[118:119], v[108:109], v[88:89]
    v_pk_mul_f32 v[120:121], v[108:109], v[90:91]
    v_pk_mul_f32 v[122:123], v[108:109], v[92:93]
    v_pk_mul_f32 v[124:125], v[108:109], v[94:95]
    v_pk_fma_f32 v[110:111], v[106:107], v[82:83], v[110:111]
    v_pk_fma_f32 v[112:113], v[106:107], v[84:85], v[112:113]
    v_pk_fma_f32 v[114:115], v[106:107], v[86:87], v[114:115]
    v_pk_fma_f32 v[116:117], v[106:107], v[88:89], v[116:117]
    v_pk_fma_f32 v[118:119], v[106:107], v[90:91], v[118:119]
    v_pk_fma_f32 v[120:121], v[106:107], v[92:93], v[120:121]
    v_pk_fma_f32 v[122:123], v[106:107], v[94:95], v[122:123]
    v_pk_fma_f32 v[124:125], v[106:107], v[96:97], v[124:125]
    v_pk_fma_f32 v[110:111], v[104:105], v[84:85], v[110:111]
    v_pk_fma_f32 v[112:113], v[104:105], v[86:87], v[112:113]
    v_pk_fma_f32 v[114:115], v[104:105], v[88:89], v[114:115]
    v_pk_fma_f32 v[116:117], v[104:105], v[90:91], v[116:117]
    v_pk_fma_f32 v[118:119], v[104:105], v[92:93], v[118:119]
    v_pk_fma_f32 v[120:121], v[104:105], v[94:95], v[120:121]
    v_pk_fma_f32 v[122:123], v[104:105], v[96:97], v[122:123]
    v_pk_fma_f32 v[124:125], v[104:105], v[98:99], v[124:125]
    v_pk_fma_f32 v[110:111], v[102:103], v[86:87], v[110:111]
    v_pk_fma_f32 v[112:113], v[102:103], v[88:89], v[112:113]
    v_pk_fma_f32 v[114:115], v[102:103], v[90:91], v[114:115]
    v_pk_fma_f32 v[116:117], v[102:103], v[92:93], v[116:117]
    v_pk_fma_f32 v[118:119], v[102:103], v[94:95], v[118:119]
    v_pk_fma_f32 v[120:121], v[102:103], v[96:97], v[120:121]
    v_pk_fma_f32 v[122:123], v[102:103], v[98:99], v[122:123]
    v_pk_fma_f32 v[124:125], v[102:103], v[100:101], v[124:125]
    s_waitcnt lgkmcnt(0)
    v_lshlrev_b32 v80, 16, v60
    v_and_b32 v81, s93, v60
    v_lshlrev_b32 v82, 16, v61
    v_and_b32 v83, s93, v61
    v_lshlrev_b32 v84, 16, v62
    v_and_b32 v85, s93, v62
    v_lshlrev_b32 v86, 16, v63
    v_and_b32 v87, s93, v63
    v_lshlrev_b32 v88, 16, v64
    v_and_b32 v89, s93, v64
    v_lshlrev_b32 v90, 16, v65
    v_and_b32 v91, s93, v65
    v_lshlrev_b32 v92, 16, v66
    v_and_b32 v93, s93, v66
    v_lshlrev_b32 v94, 16, v67
    v_and_b32 v95, s93, v67
    v_pk_mul_f32 v[110:111], v[110:111], v[80:81]
    v_pk_mul_f32 v[112:113], v[112:113], v[82:83]
    v_pk_mul_f32 v[114:115], v[114:115], v[84:85]
    v_pk_mul_f32 v[116:117], v[116:117], v[86:87]
    v_pk_mul_f32 v[118:119], v[118:119], v[88:89]
    v_pk_mul_f32 v[120:121], v[120:121], v[90:91]
    v_pk_mul_f32 v[122:123], v[122:123], v[92:93]
    v_pk_mul_f32 v[124:125], v[124:125], v[94:95]
    v_cvt_pk_bf16_f32 v48, v124, v122
    v_cvt_pk_bf16_f32 v49, v120, v118
    v_cvt_pk_bf16_f32 v50, v116, v114
    v_cvt_pk_bf16_f32 v51, v112, v110
    buffer_store_dwordx4 v[48:51], v6, s[84:87], 0 offen sc1
    v_cvt_pk_bf16_f32 v52, v125, v123
    v_cvt_pk_bf16_f32 v53, v121, v119
    v_cvt_pk_bf16_f32 v54, v117, v115
    v_cvt_pk_bf16_f32 v55, v113, v111
    buffer_store_dwordx4 v[52:55], v6, s[84:87], s15 offen sc1
    buffer_load_dword v24, v8, s[80:83], 0 offen sc1
    v_mov_b32 v18, 1
    v_mov_b32 v19, 125208
    s_mov_b64 exec, 1
    ds_add_u32 v19, v18
    s_mov_b64 exec, -1
    buffer_load_dwordx4 v[70:73], v28, s[60:63], 0 offen
    buffer_load_dwordx4 v[74:77], v28, s[60:63], 0 offen offset:16
    buffer_load_dwordx2 v[68:69], v29, s[60:63], 0 offen
    v_mov_b32 v26, 0
    v_mov_b32 v27, 0
    v_lshl_add_u32 v20, v1, 3, s95
    s_waitcnt vmcnt(3)
    v_mov_b32 v18, 1
    v_mov_b32 v19, 125192
    s_mov_b64 exec, 1
    ds_add_u32 v19, v18
    s_mov_b64 exec, -1
    s_lshl_b32 s15, s11, 7
    s_add_u32 s15, s15, 0xd80000
    s_cmp_eq_u32 s3, 0
    s_cbranch_scc0 L_if_3
    s_mov_b32 s98, 0
    v_mov_b32 v19, 125192
L_spin_4:
    ds_read_b32 v18, v19
    s_add_u32 s98, s98, 1
    s_waitcnt lgkmcnt(0)
    v_cmp_ne_u32 vcc, 4, v18
    s_cbranch_vccz L_sdone_5
    s_sleep 1
    s_cmp_lt_u32 s98, 0x1000000
    s_cbranch_scc1 L_spin_4
L_sdone_5:
    s_mov_b32 s98, 0
L_flag_6:
    v_cmp_gt_u32 vcc, 4, v24
    s_cbranch_vccz L_flagok_7
    s_sleep 2
    buffer_load_dword v24, v8, s[80:83], 0 offen sc1
    s_add_u32 s98, s98, 1
    s_waitcnt vmcnt(0)
    s_cmp_lt_u32 s98, 0x100000
    s_cbranch_scc1 L_flag_6
L_flagok_7:
    s_atomic_add s16, s[84:85], s15
L_if_3:
    v_lshrrev_b32 v31, 7, v0
    v_mul_u32_u24 v31, 16640, v31
    v_lshl_add_u32 v31, v30, 5, v31
    v_add_u32 v31, 130592, v31
    s_waitcnt vmcnt(0)
    v_alignbit_b32 v128, v70, v69, 16
    v_mov_b32 v136, v69
    v_alignbit_b32 v144, v69, v68, 16
    v_alignbit_b32 v129, v71, v70, 16
    v_mov_b32 v137, v70
    v_alignbit_b32 v145, v70, v69, 16
    v_alignbit_b32 v130, v72, v71, 16
    v_mov_b32 v138, v71
    v_alignbit_b32 v146, v71, v70, 16
    v_alignbit_b32 v131, v73, v72, 16
    v_mov_b32 v139, v72
    v_alignbit_b32 v147, v72, v71, 16
    v_alignbit_b32 v132, v74, v73, 16
    v_mov_b32 v140, v73
    v_alignbit_b32 v148, v73, v72, 16
    v_alignbit_b32 v133, v75, v74, 16
    v_mov_b32 v141, v74
    v_alignbit_b32 v149, v74, v73, 16
    v_alignbit_b32 v134, v76, v75, 16
    v_mov_b32 v142, v75
    v_alignbit_b32 v150, v75, v74, 16
    v_alignbit_b32 v135, v77, v76, 16
    v_mov_b32 v143, v76
    v_alignbit_b32 v151, v76, v75, 16
    ds_write_b128 v31, v[70:73] offset:0
    ds_write_b128 v31, v[74:77] offset:16
    ds_write_b128 v31, v[128:131] offset:4160
    ds_write_b128 v31, v[132:135] offset:4176
    ds_write_b128 v31, v[136:139] offset:8320
    ds_write_b128 v31, v[140:143] offset:8336
    ds_write_b128 v31, v[144:147] offset:12480
    ds_write_b128 v31, v[148:151] offset:12496
    s_waitcnt lgkmcnt(0)
    v_mov_b32 v18, 1
    v_mov_b32 v19, 125188
    s_mov_b64 exec, 1
    ds_add_u32 v19, v18
    s_mov_b64 exec, -1
    s_mov_b32 s98, 0
    v_mov_b32 v19, 125188
L_spin_8:
    ds_read_b32 v18, v19
    s_add_u32 s98, s98, 1
    s_waitcnt lgkmcnt(0)
    v_cmp_ne_u32 vcc, 4, v18
    s_cbranch_vccz L_sdone_9
    s_sleep 1
    s_cmp_lt_u32 s98, 0x1000000
    s_cbranch_scc1 L_spin_8
L_sdone_9:
    ds_read_b64 v[128:129], v15 offset:0
    ds_read_b64 v[130:131], v15 offset:8
    ds_read_b64 v[132:133], v15 offset:512
    ds_read_b64 v[134:135], v15 offset:520
    ds_read_b64 v[136:137], v15 offset:1024
    ds_read_b64 v[138:139], v15 offset:1032
    ds_read_b64 v[140:141], v15 offset:1536
    ds_read_b64 v[142:143], v15 offset:1544
    ds_read_b64 v[144:145], v15 offset:2048
    ds_read_b64 v[146:147], v15 offset:2056
    ds_read_b64 v[148:149], v15 offset:2560
    ds_read_b64 v[150:151], v15 offset:2568
    ds_read_b64 v[152:153], v15 offset:3072
    ds_read_b64 v[154:155], v15 offset:3080
    ds_read_b64 v[156:157], v15 offset:3584
    ds_read_b64 v[158:159], v15 offset:3592
    ds_read_b64 v[160:161], v15 offset:64
    ds_read_b64 v[162:163], v15 offset:72
    ds_read_b64 v[164:165], v15 offset:576
    ds_read_b64 v[166:167], v15 offset:584
    ds_read_b64 v[168:169], v15 offset:1088
    ds_read_b64 v[170:171], v15 offset:1096
    ds_read_b64 v[172:173], v15 offset:1600
    ds_read_b64 v[174:175], v15 offset:1608
    ds_read_b64 v[176:177], v15 offset:2112
    ds_read_b64 v[178:179], v15 offset:2120
    ds_read_b64 v[180:181], v15 offset:2624
    ds_read_b64 v[182:183], v15 offset:2632
    ds_read_b64 v[184:185], v15 offset:3136
    ds_read_b64 v[186:187], v15 offset:3144
    ds_read_b64 v[188:189], v15 offset:3648
    ds_read_b64 v[190:191], v15 offset:3656
    ds_read_b64 v[192:193], v15 offset:128
    ds_read_b64 v[194:195], v15 offset:136
    ds_read_b64 v[196:197], v15 offset:640
    ds_read_b64 v[198:199], v15 offset:648
    ds_read_b64 v[200:201], v15 offset:1152
    ds_read_b64 v[202:203], v15 offset:1160
    ds_read_b64 v[204:205], v15 offset:1664
    ds_read_b64 v[206:207], v15 offset:1672
    ds_read_b64 v[208:209], v15 offset:2176
    ds_read_b64 v[210:211], v15 offset:2184
    ds_read_b64 v[212:213], v15 offset:2688
    ds_read_b64 v[214:215], v15 offset:2696
    ds_read_b64 v[216:217], v15 offset:3200
    ds_read_b64 v[218:219], v15 offset:3208
    ds_read_b64 v[220:221], v15 offset:3712
    ds_read_b64 v[222:223], v15 offset:3720
    ds_read_b64 v[224:225], v15 offset:192
    ds_read_b64 v[226:227], v15 offset:200
    ds_read_b64 v[228:229], v15 offset:704
    ds_read_b64 v[230:231], v15 offset:712
    ds_read_b64 v[232:233], v15 offset:1216
    ds_read_b64 v[234:235], v15 offset:1224
    ds_read_b64 v[236:237], v15 offset:1728
    ds_read_b64 v[238:239], v15 offset:1736
    ds_read_b64 v[240:241], v15 offset:2240
    ds_read_b64 v[242:243], v15 offset:2248
    ds_read_b64 v[244:245], v15 offset:2752
    ds_read_b64 v[246:247], v15 offset:2760
    ds_read_b64 v[248:249], v15 offset:3264
    ds_read_b64 v[250:251], v15 offset:3272
    ds_read_b64 v[252:253], v15 offset:3776
    ds_read_b64 v[254:255], v15 offset:3784
    s_cmp_eq_u32 s3, 0
    s_cbranch_scc0 L_if_10
    s_mov_b32 s98, 0
L_poll_11:
    s_mov_b32 s99, 0
    s_atomic_add s99, s[84:85], s15 glc
    s_add_u32 s98, s98, 1
    s_waitcnt lgkmcnt(0)
    s_cmp_ge_u32 s99, 32
    s_cbranch_scc1 L_pdone_12
    s_sleep 1
    s_cmp_lt_u32 s98, 0x100000
    s_cbranch_scc1 L_poll_11
L_pdone_12:
    v_mov_b32 v18, 1
    v_mov_b32 v19, 125184
    s_mov_b64 exec, 1
    ds_add_u32 v19, v18
    s_mov_b64 exec, -1
L_if_10:
    s_waitcnt lgkmcnt(0)
    v_mov_b32 v18, 1
    v_mov_b32 v19, 125184
    s_mov_b64 exec, 1
    ds_add_u32 v19, v18
    s_mov_b64 exec, -1
    s_mov_b32 s98, 0
    v_mov_b32 v19, 125184
L_spin_13:
    ds_read_b32 v18, v19
    s_add_u32 s98, s98, 1
    s_waitcnt lgkmcnt(0)
    v_cmp_ne_u32 vcc, 5, v18
    s_cbranch_vccz L_sdone_14
    s_sleep 1
    s_cmp_lt_u32 s98, 0x1000000
    s_cbranch_scc1 L_spin_13
L_sdone_14:
    s_add_u32 m0, s95, 512
    s_nop 0
    buffer_load_dwordx4 v7, s[84:87], s92 offen offset:0 sc1 lds
    buffer_load_dwordx4 v7, s[84:87], s92 offen offset:1024 sc1 lds
    buffer_load_dwordx4 v7, s[84:87], s92 offen offset:2048 sc1 lds
    buffer_load_dwordx4 v7, s[84:87], s92 offen offset:3072 sc1 lds
    ds_write_b64 v20, v[26:27]
    s_waitcnt vmcnt(3)
    ds_read_b128 v[40:43], v16 offset:192
    ds_read_b128 v[44:47], v16 offset:704
    s_waitcnt vmcnt(2)
    ds_read_b128 v[48:51], v16 offset:1216
    ds_read_b128 v[52:55], v16 offset:1728
    s_waitcnt vmcnt(1)
    ds_read_b128 v[56:59], v16 offset:2240
    ds_read_b128 v[60:63], v16 offset:2752
    s_waitcnt vmcnt(0)
    ds_read_b128 v[64:67], v16 offset:3264
    ds_read_b128 v[68:71], v16 offset:3776
    s_waitcnt lgkmcnt(7)
    v_mfma_f32_16x16x32_bf16 v[104:107], v[128:131], v[40:43], 0
    v_mfma_f32_16x16x32_bf16 v[108:111], v[132:135], v[40:43], 0
    v_mfma_f32_16x16x32_bf16 v[112:115], v[136:139], v[40:43], 0
    v_mfma_f32_16x16x32_bf16 v[116:119], v[140:143], v[40:43], 0
    v_mfma_f32_16x16x32_bf16 v[120:123], v[144:147], v[40:43], 0
    v_mfma_f32_16x16x32_bf16 v[124:127], v[148:151], v[40:43], 0
    v_mfma_f32_16x16x32_bf16 v[32:35], v[152:155], v[40:43], 0
    v_mfma_f32_16x16x32_bf16 v[36:39], v[156:159], v[40:43], 0
    s_waitcnt lgkmcnt(6)
    v_mfma_f32_16x16x32_bf16 v[108:111], v[128:131], v[44:47], v[108:111]
    ds_read_b128 v[72:75], v16 offset:128
    v_mfma_f32_16x16x32_bf16 v[112:115], v[132:135], v[44:47], v[112:115]
    ds_read_b128 v[76:79], v16 offset:640
    v_mfma_f32_16x16x32_bf16 v[116:119], v[136:139], v[44:47], v[116:119]
    ds_read_b128 v[80:83], v16 offset:1152
    v_mfma_f32_16x16x32_bf16 v[120:123], v[140:143], v[44:47], v[120:123]
    ds_read_b128 v[84:87], v16 offset:1664
    v_mfma_f32_16x16x32_bf16 v[124:127], v[144:147], v[44:47], v[124:127]
    v_mfma_f32_16x16x32_bf16 v[32:35], v[148:151], v[44:47], v[32:35]
    v_mfma_f32_16x16x32_bf16 v[36:39], v[152:155], v[44:47], v[36:39]
    s_waitcnt lgkmcnt(9)
    v_mfma_f32_16x16x32_bf16 v[112:115], v[128:131], v[48:51], v[112:115]
    ds_read_b128 v[88:91], v16 offset:2176
    v_mfma_f32_16x16x32_bf16 v[116:119], v[132:135], v[48:51], v[116:119]
    ds_read_b128 v[92:95], v16 offset:2688
    v_mfma_f32_16x16x32_bf16 v[120:123], v[136:139], v[48:51], v[120:123]
    ds_read_b128 v[96:99], v16 offset:3200
    v_mfma_f32_16x16x32_bf16 v[124:127], v[140:143], v[48:51], v[124:127]
    ds_read_b128 v[100:103], v16 offset:3712
    v_mfma_f32_16x16x32_bf16 v[32:35], v[144:147], v[48:51], v[32:35]
    v_mfma_f32_16x16x32_bf16 v[36:39], v[148:151], v[48:51], v[36:39]
    s_waitcnt lgkmcnt(12)
    v_mfma_f32_16x16x32_bf16 v[116:119], v[128:131], v[52:55], v[116:119]
    v_mfma_f32_16x16x32_bf16 v[120:123], v[132:135], v[52:55], v[120:123]
    v_mfma_f32_16x16x32_bf16 v[124:127], v[136:139], v[52:55], v[124:127]
    v_mfma_f32_16x16x32_bf16 v[32:35], v[140:143], v[52:55], v[32:35]
    v_mfma_f32_16x16x32_bf16 v[36:39], v[144:147], v[52:55], v[36:39]
    s_waitcnt lgkmcnt(11)
    v_mfma_f32_16x16x32_bf16 v[120:123], v[128:131], v[56:59], v[120:123]
    v_mfma_f32_16x16x32_bf16 v[124:127], v[132:135], v[56:59], v[124:127]
    v_mfma_f32_16x16x32_bf16 v[32:35], v[136:139], v[56:59], v[32:35]
    v_mfma_f32_16x16x32_bf16 v[36:39], v[140:143], v[56:59], v[36:39]
    s_waitcnt lgkmcnt(10)
    v_mfma_f32_16x16x32_bf16 v[124:127], v[128:131], v[60:63], v[124:127]
    v_mfma_f32_16x16x32_bf16 v[32:35], v[132:135], v[60:63], v[32:35]
    v_mfma_f32_16x16x32_bf16 v[36:39], v[136:139], v[60:63], v[36:39]
    s_waitcnt lgkmcnt(9)
    v_mfma_f32_16x16x32_bf16 v[32:35], v[128:131], v[64:67], v[32:35]
    v_mfma_f32_16x16x32_bf16 v[36:39], v[132:135], v[64:67], v[36:39]
    s_waitcnt lgkmcnt(8)
    v_mfma_f32_16x16x32_bf16 v[36:39], v[128:131], v[68:71], v[36:39]
    s_waitcnt lgkmcnt(7)
    v_mfma_f32_16x16x32_bf16 v[104:107], v[160:163], v[72:75], v[104:107]
    v_mfma_f32_16x16x32_bf16 v[108:111], v[164:167], v[72:75], v[108:111]
    v_mfma_f32_16x16x32_bf16 v[112:115], v[168:171], v[72:75], v[112:115]
    v_mfma_f32_16x16x32_bf16 v[116:119], v[172:175], v[72:75], v[116:119]
    v_mfma_f32_16x16x32_bf16 v[120:123], v[176:179], v[72:75], v[120:123]
    v_mfma_f32_16x16x32_bf16 v[124:127], v[180:183], v[72:75], v[124:127]
    v_mfma_f32_16x16x32_bf16 v[32:35], v[184:187], v[72:75], v[32:35]
    v_mfma_f32_16x16x32_bf16 v[36:39], v[188:191], v[72:75], v[36:39]
    s_waitcnt lgkmcnt(6)
    v_mfma_f32_16x16x32_bf16 v[108:111], v[160:163], v[76:79], v[108:111]
    ds_read_b128 v[40:43], v16 offset:64
    v_mfma_f32_16x16x32_bf16 v[112:115], v[164:167], v[76:79], v[112:115]
    ds_read_b128 v[44:47], v16 offset:576
    v_mfma_f32_16x16x32_bf16 v[116:119], v[168:171], v[76:79], v[116:119]
    ds_read_b128 v[48:51], v16 offset:1088
    v_mfma_f32_16x16x32_bf16 v[120:123], v[172:175], v[76:79], v[120:123]
    ds_read_b128 v[52:55], v16 offset:1600
    v_mfma_f32_16x16x32_bf16 v[124:127], v[176:179], v[76:79], v[124:127]
    v_mfma_f32_16x16x32_bf16 v[32:35], v[180:183], v[76:79], v[32:35]
    v_mfma_f32_16x16x32_bf16 v[36:39], v[184:187], v[76:79], v[36:39]
    s_waitcnt lgkmcnt(9)
    v_mfma_f32_16x16x32_bf16 v[112:115], v[160:163], v[80:83], v[112:115]
    ds_read_b128 v[56:59], v16 offset:2112
    v_mfma_f32_16x16x32_bf16 v[116:119], v[164:167], v[80:83], v[116:119]
    ds_read_b128 v[60:63], v16 offset:2624
    v_mfma_f32_16x16x32_bf16 v[120:123], v[168:171], v[80:83], v[120:123]
    ds_read_b128 v[64:67], v16 offset:3136
    v_mfma_f32_16x16x32_bf16 v[124:127], v[172:175], v[80:83], v[124:127]
    ds_read_b128 v[68:71], v16 offset:3648
    v_mfma_f32_16x16x32_bf16 v[32:35], v[176:179], v[80:83], v[32:35]
    v_mfma_f32_16x16x32_bf16 v[36:39], v[180:183], v[80:83], v[36:39]
    s_waitcnt lgkmcnt(12)
    v_mfma_f32_16x16x32_bf16 v[116:119], v[160:163], v[84:87], v[116:119]
    v_mfma_f32_16x16x32_bf16 v[120:123], v[164:167], v[84:87], v[120:123]
    v_mfma_f32_16x16x32_bf16 v[124:127], v[168:171], v[84:87], v[124:127]
    v_mfma_f32_16x16x32_bf16 v[32:35], v[172:175], v[84:87], v[32:35]
    v_mfma_f32_16x16x32_bf16 v[36:39], v[176:179], v[84:87], v[36:39]
    s_waitcnt lgkmcnt(11)
    v_mfma_f32_16x16x32_bf16 v[120:123], v[160:163], v[88:91], v[120:123]
    v_mfma_f32_16x16x32_bf16 v[124:127], v[164:167], v[88:91], v[124:127]
    v_mfma_f32_16x16x32_bf16 v[32:35], v[168:171], v[88:91], v[32:35]
    v_mfma_f32_16x16x32_bf16 v[36:39], v[172:175], v[88:91], v[36:39]
    s_waitcnt lgkmcnt(10)
    v_mfma_f32_16x16x32_bf16 v[124:127], v[160:163], v[92:95], v[124:127]
    v_mfma_f32_16x16x32_bf16 v[32:35], v[164:167], v[92:95], v[32:35]
    v_mfma_f32_16x16x32_bf16 v[36:39], v[168:171], v[92:95], v[36:39]
    s_waitcnt lgkmcnt(9)
    v_mfma_f32_16x16x32_bf16 v[32:35], v[160:163], v[96:99], v[32:35]
    v_mfma_f32_16x16x32_bf16 v[36:39], v[164:167], v[96:99], v[36:39]
    s_waitcnt lgkmcnt(8)
    v_mfma_f32_16x16x32_bf16 v[36:39], v[160:163], v[100:103], v[36:39]
    s_waitcnt lgkmcnt(7)
    v_mfma_f32_16x16x32_bf16 v[104:107], v[192:195], v[40:43], v[104:107]
    v_mfma_f32_16x16x32_bf16 v[108:111], v[196:199], v[40:43], v[108:111]
    v_mfma_f32_16x16x32_bf16 v[112:115], v[200:203], v[40:43], v[112:115]
    v_mfma_f32_16x16x32_bf16 v[116:119], v[204:207], v[40:43], v[116:119]
    v_mfma_f32_16x16x32_bf16 v[120:123], v[208:211], v[40:43], v[120:123]
    v_mfma_f32_16x16x32_bf16 v[124:127], v[212:215], v[40:43], v[124:127]
    v_mfma_f32_16x16x32_bf16 v[32:35], v[216:219], v[40:43], v[32:35]
    v_mfma_f32_16x16x32_bf16 v[36:39], v[220:223], v[40:43], v[36:39]
    s_waitcnt lgkmcnt(6)
    v_mfma_f32_16x16x32_bf16 v[108:111], v[192:195], v[44:47], v[108:111]
    ds_read_b128 v[72:75], v16 offset:0
    v_mfma_f32_16x16x32_bf16 v[112:115], v[196:199], v[44:47], v[112:115]
    ds_read_b128 v[76:79], v16 offset:512
    v_mfma_f32_16x16x32_bf16 v[116:119], v[200:203], v[44:47], v[116:119]
    ds_read_b128 v[80:83], v16 offset:1024
    v_mfma_f32_16x16x32_bf16 v[120:123], v[204:207], v[44:47], v[120:123]
    ds_read_b128 v[84:87], v16 offset:1536
    v_mfma_f32_16x16x32_bf16 v[124:127], v[208:211], v[44:47], v[124:127]
    v_mfma_f32_16x16x32_bf16 v[32:35], v[212:215], v[44:47], v[32:35]
    v_mfma_f32_16x16x32_bf16 v[36:39], v[216:219], v[44:47], v[36:39]
    s_waitcnt lgkmcnt(9)
    v_mfma_f32_16x16x32_bf16 v[112:115], v[192:195], v[48:51], v[112:115]
    ds_read_b128 v[88:91], v16 offset:2048
    v_mfma_f32_16x16x32_bf16 v[116:119], v[196:199], v[48:51], v[116:119]
    ds_read_b128 v[92:95], v16 offset:2560
    v_mfma_f32_16x16x32_bf16 v[120:123], v[200:203], v[48:51], v[120:123]
    ds_read_b128 v[96:99], v16 offset:3072
    v_mfma_f32_16x16x32_bf16 v[124:127], v[204:207], v[48:51], v[124:127]
    ds_read_b128 v[100:103], v16 offset:3584
    v_mfma_f32_16x16x32_bf16 v[32:35], v[208:211], v[48:51], v[32:35]
    v_mfma_f32_16x16x32_bf16 v[36:39], v[212:215], v[48:51], v[36:39]
    s_waitcnt lgkmcnt(12)
    v_mfma_f32_16x16x32_bf16 v[116:119], v[192:195], v[52:55], v[116:119]
    v_mfma_f32_16x16x32_bf16 v[120:123], v[196:199], v[52:55], v[120:123]
    v_mfma_f32_16x16x32_bf16 v[124:127], v[200:203], v[52:55], v[124:127]
    v_mfma_f32_16x16x32_bf16 v[32:35], v[204:207], v[52:55], v[32:35]
    v_mfma_f32_16x16x32_bf16 v[36:39], v[208:211], v[52:55], v[36:39]
    s_waitcnt lgkmcnt(11)
    v_mfma_f32_16x16x32_bf16 v[120:123], v[192:195], v[56:59], v[120:123]
    v_mfma_f32_16x16x32_bf16 v[124:127], v[196:199], v[56:59], v[124:127]
    v_mfma_f32_16x16x32_bf16 v[32:35], v[200:203], v[56:59], v[32:35]
    v_mfma_f32_16x16x32_bf16 v[36:39], v[204:207], v[56:59], v[36:39]
    s_waitcnt lgkmcnt(10)
    v_mfma_f32_16x16x32_bf16 v[124:127], v[192:195], v[60:63], v[124:127]
    v_mfma_f32_16x16x32_bf16 v[32:35], v[196:199], v[60:63], v[32:35]
    v_mfma_f32_16x16x32_bf16 v[36:39], v[200:203], v[60:63], v[36:39]
    s_waitcnt lgkmcnt(9)
    v_mfma_f32_16x16x32_bf16 v[32:35], v[192:195], v[64:67], v[32:35]
    v_mfma_f32_16x16x32_bf16 v[36:39], v[196:199], v[64:67], v[36:39]
    s_waitcnt lgkmcnt(8)
    v_mfma_f32_16x16x32_bf16 v[36:39], v[192:195], v[68:71], v[36:39]
    s_waitcnt lgkmcnt(7)
    v_mfma_f32_16x16x32_bf16 v[104:107], v[224:227], v[72:75], v[104:107]
    v_mfma_f32_16x16x32_bf16 v[108:111], v[228:231], v[72:75], v[108:111]
    v_mfma_f32_16x16x32_bf16 v[112:115], v[232:235], v[72:75], v[112:115]
    v_mfma_f32_16x16x32_bf16 v[116:119], v[236:239], v[72:75], v[116:119]
    v_mfma_f32_16x16x32_bf16 v[120:123], v[240:243], v[72:75], v[120:123]
    v_mfma_f32_16x16x32_bf16 v[124:127], v[244:247], v[72:75], v[124:127]
    v_mfma_f32_16x16x32_bf16 v[32:35], v[248:251], v[72:75], v[32:35]
    v_mfma_f32_16x16x32_bf16 v[36:39], v[252:255], v[72:75], v[36:39]
    s_waitcnt lgkmcnt(6)
    v_mfma_f32_16x16x32_bf16 v[108:111], v[224:227], v[76:79], v[108:111]
    v_mfma_f32_16x16x32_bf16 v[112:115], v[228:231], v[76:79], v[112:115]
    v_mfma_f32_16x16x32_bf16 v[116:119], v[232:235], v[76:79], v[116:119]
    v_mfma_f32_16x16x32_bf16 v[120:123], v[236:239], v[76:79], v[120:123]
    v_mfma_f32_16x16x32_bf16 v[124:127], v[240:243], v[76:79], v[124:127]
    v_mfma_f32_16x16x32_bf16 v[32:35], v[244:247], v[76:79], v[32:35]
    v_mfma_f32_16x16x32_bf16 v[36:39], v[248:251], v[76:79], v[36:39]
    s_waitcnt lgkmcnt(5)
    v_mfma_f32_16x16x32_bf16 v[112:115], v[224:227], v[80:83], v[112:115]
    v_mfma_f32_16x16x32_bf16 v[116:119], v[228:231], v[80:83], v[116:119]
    v_mfma_f32_16x16x32_bf16 v[120:123], v[232:235], v[80:83], v[120:123]
    v_mfma_f32_16x16x32_bf16 v[124:127], v[236:239], v[80:83], v[124:127]
    v_mfma_f32_16x16x32_bf16 v[32:35], v[240:243], v[80:83], v[32:35]
    v_mfma_f32_16x16x32_bf16 v[36:39], v[244:247], v[80:83], v[36:39]
    ds_write_b128 v17, v[104:107] offset:0
    s_waitcnt lgkmcnt(5)
    v_mfma_f32_16x16x32_bf16 v[116:119], v[224:227], v[84:87], v[116:119]
    v_mfma_f32_16x16x32_bf16 v[120:123], v[228:231], v[84:87], v[120:123]
    v_mfma_f32_16x16x32_bf16 v[124:127], v[232:235], v[84:87], v[124:127]
    v_mfma_f32_16x16x32_bf16 v[32:35], v[236:239], v[84:87], v[32:35]
    v_mfma_f32_16x16x32_bf16 v[36:39], v[240:243], v[84:87], v[36:39]
    ds_write_b128 v17, v[108:111] offset:1024
    s_waitcnt lgkmcnt(5)
    v_mfma_f32_16x16x32_bf16 v[120:123], v[224:227], v[88:91], v[120:123]
    v_mfma_f32_16x16x32_bf16 v[124:127], v[228:231], v[88:91], v[124:127]
    v_mfma_f32_16x16x32_bf16 v[32:35], v[232:235], v[88:91], v[32:35]
    v_mfma_f32_16x16x32_bf16 v[36:39], v[236:239], v[88:91], v[36:39]
    ds_write_b128 v17, v[112:115] offset:2048
    s_waitcnt lgkmcnt(5)
    v_mfma_f32_16x16x32_bf16 v[124:127], v[224:227], v[92:95], v[124:127]
    v_mfma_f32_16x16x32_bf16 v[32:35], v[228:231], v[92:95], v[32:35]
    v_mfma_f32_16x16x32_bf16 v[36:39], v[232:235], v[92:95], v[36:39]
    ds_write_b128 v17, v[116:119] offset:3072
    s_waitcnt lgkmcnt(5)
    v_mfma_f32_16x16x32_bf16 v[32:35], v[224:227], v[96:99], v[32:35]
    v_mfma_f32_16x16x32_bf16 v[36:39], v[228:231], v[96:99], v[36:39]
    ds_write_b128 v17, v[120:123] offset:4096
    s_waitcnt lgkmcnt(5)
    v_mfma_f32_16x16x32_bf16 v[36:39], v[224:227], v[100:103], v[36:39]
    ds_write_b128 v17, v[124:127] offset:5120
    s_nop 2
    ds_write_b128 v17, v[32:35] offset:6144
    s_nop 2
    ds_write_b128 v17, v[36:39] offset:7168
    s_waitcnt lgkmcnt(0)
    s_barrier
    v_lshrrev_b32 v20, 5, v1
    v_bfe_u32 v21, v1, 2, 2
    v_bfe_u32 v22, v1, 4, 1
    v_and_b32 v23, 3, v1
    v_lshl_add_u32 v25, v20, 3, v21
    v_mul_u32_u24 v26, 96, v25
    v_mul_u32_u24 v27, 3200, v22
    v_add_u32 v26, v26, v27
    v_lshl_add_u32 v12, v23, 3, v26
    v_add_u32 v13, 0x10000, v12
    v_add_u32 v16, 0x10000, v7
    v_add_u32 v6, 0x20000, v7
    v_mov_b32 v14, 103296
    s_lshl_b32 s13, s3, 2
    s_add_u32 s13, s13, 103296
    v_mov_b32 v5, s13
    v_mov_b32 v15, 1
    v_lshrrev_b32 v26, 1, v25
    v_lshlrev_b32 v26, 7, v26
    v_lshl_add_u32 v27, v22, 2, v23
    v_lshl_add_u32 v26, v27, 4, v26
    v_and_b32 v27, 1, v21
    v_lshl_add_u32 v26, v27, 3, v26
    s_lshl_b32 s96, s3, 13
    s_add_u32 s96, s96, 131072
    v_add_u32 v18, s96, v26
    v_add_u32 v19, s96, v7
    v_lshlrev_b32 v11, 4, v20
    v_add_u32 v11, 102400, v11
    s_mul_i32 s13, s3, 768
    s_add_u32 s13, s13, 103424
    v_lshl_add_u32 v17, v1, 2, s13
    s_add_u32 s97, s96, 4096
    s_lshl_b32 s95, s6, 2
    s_add_u32 s95, s95, s3
    s_lshl_b32 s94, s95, 15
    s_add_u32 s94, s94, 0x400000
    s_add_u32 s13, s9, 0
    s_and_b32 s13, s13, 7
    s_lshl_b32 s13, s13, 12
    s_add_u32 s36, s13, s94
    s_add_u32 s13, s9, 1
    s_and_b32 s13, s13, 7
    s_lshl_b32 s13, s13, 12
    s_add_u32 s37, s13, s94
    s_add_u32 s13, s9, 2
    s_and_b32 s13, s13, 7
    s_lshl_b32 s13, s13, 12
    s_add_u32 s38, s13, s94
    s_add_u32 s13, s9, 3
    s_and_b32 s13, s13, 7
    s_lshl_b32 s13, s13, 12
    s_add_u32 s39, s13, s94
    s_add_u32 s13, s9, 4
    s_and_b32 s13, s13, 7
    s_lshl_b32 s13, s13, 12
    s_add_u32 s40, s13, s94
    s_add_u32 s13, s9, 5
    s_and_b32 s13, s13, 7
    s_lshl_b32 s13, s13, 12
    s_add_u32 s41, s13, s94
    s_add_u32 s13, s9, 6
    s_and_b32 s13, s13, 7
    s_lshl_b32 s13, s13, 12
    s_add_u32 s42, s13, s94
    s_add_u32 s13, s9, 7
    s_and_b32 s13, s13, 7
    s_lshl_b32 s13, s13, 12
    s_add_u32 s43, s13, s94
    s_mul_i32 s94, s95, 114688
    s_add_u32 s94, s94, 0x600000
    s_lshl_b32 s13, s7, 12
    s_add_u32 s88, s94, s13
    s_mul_i32 s13, s7, 3072
    s_add_u32 s89, s94, s13
    s_add_u32 s89, s89, 65536
    s_lshr_b32 s13, s3, 1
    s_lshl_b32 s14, s6, 1
    s_add_u32 s13, s13, s14
    s_lshl_b32 s13, s13, 2
    s_lshr_b32 s14, s7, 2
    s_add_u32 s13, s13, s14
    s_lshl_b32 s13, s13, 10
    s_add_u32 s91, s13, 0xda0100
    s_add_u32 s92, s91, 256
    s_lshl_b32 s13, s3, 12
    s_add_u32 s13, s13, 73728
    v_add_u32 v9, s13, v7
    s_add_u32 s13, s96, 6144
    v_mov_b32 v23, s13
    v_lshlrev_b32 v24, 13, v1
    v_add_u32 v24, 137216, v24
    s_barrier
    s_cmp_lg_u32 s3, 0
    s_cbranch_scc1 L_b2w
    s_and_b32 s14, s5, 7
    s_lshl_b32 s14, s14, 7
    s_add_u32 s14, s14, 0xd84000
    s_atomic_add s16, s[84:85], s14
    s_add_u32 s14, s14, 1024
    s_atomic_add s16, s[84:85], s14
    s_add_u32 s14, s14, 1024
    s_atomic_add s16, s[84:85], s14
    s_add_u32 s14, s14, 1024
    s_atomic_add s16, s[84:85], s14
    s_add_u32 s14, s14, 1024
    s_atomic_add s16, s[84:85], s14
    s_add_u32 s14, s14, 1024
    s_atomic_add s16, s[84:85], s14
    s_add_u32 s14, s14, 1024
    s_atomic_add s16, s[84:85], s14
    s_add_u32 s14, s14, 1024
    s_atomic_add s16, s[84:85], s14
    s_and_b32 s13, s2, 7
    s_mul_i32 s13, s13, 1024
    s_add_u32 s13, s13, 0xd84000
    s_mov_b32 s98, 0
L_fp_15:
    s_mov_b32 s14, s13
    s_mov_b32 s44, 0
    s_atomic_add s44, s[84:85], s14 glc
    s_add_u32 s14, s14, 128
    s_mov_b32 s45, 0
    s_atomic_add s45, s[84:85], s14 glc
    s_add_u32 s14, s14, 128
    s_mov_b32 s46, 0
    s_atomic_add s46, s[84:85], s14 glc
    s_add_u32 s14, s14, 128
    s_mov_b32 s47, 0
    s_atomic_add s47, s[84:85], s14 glc
    s_add_u32 s14, s14, 128
    s_mov_b32 s48, 0
    s_atomic_add s48, s[84:85], s14 glc
    s_add_u32 s14, s14, 128
    s_mov_b32 s49, 0
    s_atomic_add s49, s[84:85], s14 glc
    s_add_u32 s14, s14, 128
    s_mov_b32 s50, 0
    s_atomic_add s50, s[84:85], s14 glc
    s_add_u32 s14, s14, 128
    s_mov_b32 s51, 0
    s_atomic_add s51, s[84:85], s14 glc
    s_add_u32 s98, s98, 1
    s_waitcnt lgkmcnt(0)
    s_add_u32 s44, s44, s45
    s_add_u32 s44, s44, s46
    s_add_u32 s44, s44, s47
    s_add_u32 s44, s44, s48
    s_add_u32 s44, s44, s49
    s_add_u32 s44, s44, s50
    s_add_u32 s44, s44, s51
    s_cmp_ge_u32 s44, 256
    s_cbranch_scc1 L_fd_16
    s_sleep 1
    s_cmp_lt_u32 s98, 0x100000
    s_cbranch_scc1 L_fp_15
L_fd_16:
    v_mov_b32 v21, 1
    s_mov_b64 exec, 15
    ds_write_b32 v24, v21
    s_mov_b64 exec, -1
L_b2w:
    s_mov_b32 s98, 0
L_spin_17:
    ds_read_b32 v21, v23
    s_add_u32 s98, s98, 1
    s_waitcnt lgkmcnt(0)
    v_cmp_ne_u32 vcc, 1, v21
    s_cbranch_vccz L_sdone_18
    s_sleep 1
    s_cmp_lt_u32 s98, 0x1000000
    s_cbranch_scc1 L_spin_17
L_sdone_18:
    s_setprio 0
    s_mov_b32 m0, s96
    s_nop 0
    buffer_load_dwordx4 v7, s[84:87], s36 offen offset:0 sc1 lds
    buffer_load_dwordx4 v7, s[84:87], s36 offen offset:1024 sc1 lds
    buffer_load_dwordx4 v7, s[84:87], s36 offen offset:2048 sc1 lds
    buffer_load_dwordx4 v7, s[84:87], s36 offen offset:3072 sc1 lds
    s_mov_b32 m0, s97
    s_nop 0
    buffer_load_dwordx4 v7, s[84:87], s37 offen offset:0 sc1 lds
    buffer_load_dwordx4 v7, s[84:87], s37 offen offset:1024 sc1 lds
    buffer_load_dwordx4 v7, s[84:87], s37 offen offset:2048 sc1 lds
    buffer_load_dwordx4 v7, s[84:87], s37 offen offset:3072 sc1 lds
    s_barrier
    s_lshr_b32 s13, s3, 1
    s_cmp_eq_u32 s13, s8
    s_cselect_b32 s90, 1, 0
    s_and_b32 s13, s3, 1
    s_lshl_b32 s13, s13, 12
    s_add_u32 s13, s13, 90112
    v_add_u32 v20, s13, v7
    ds_read_b64_tr_b16 v[32:33], v12 offset:0
    ds_read_b64_tr_b16 v[34:35], v12 offset:384
    ds_read_b64_tr_b16 v[36:37], v12 offset:32
    ds_read_b64_tr_b16 v[38:39], v12 offset:416
    ds_read_b64_tr_b16 v[40:41], v12 offset:64
    ds_read_b64_tr_b16 v[42:43], v12 offset:448
    ds_read_b64_tr_b16 v[44:45], v12 offset:1536
    ds_read_b64_tr_b16 v[46:47], v12 offset:1920
    ds_read_b64_tr_b16 v[48:49], v12 offset:1568
    ds_read_b64_tr_b16 v[50:51], v12 offset:1952
    s_waitcnt vmcnt(7)
    ds_read_b64_tr_b16 v[128:129], v18 offset:0
    ds_read_b64_tr_b16 v[130:131], v18 offset:256
    s_waitcnt lgkmcnt(0)
    v_mfma_f32_32x32x16_bf16 v[64:79], v[32:35], v[128:131], 0
    ds_read_b64_tr_b16 v[52:53], v12 offset:1600
    ds_read_b64_tr_b16 v[54:55], v12 offset:1984
    s_waitcnt vmcnt(6)
    ds_read_b64_tr_b16 v[132:133], v18 offset:1024
    ds_read_b64_tr_b16 v[134:135], v18 offset:1280
    v_mfma_f32_32x32x16_bf16 v[80:95], v[36:39], v[128:131], 0
    ds_read_b64_tr_b16 v[56:57], v12 offset:6400
    ds_read_b64_tr_b16 v[58:59], v12 offset:6784
    v_mfma_f32_32x32x16_bf16 v[96:111], v[40:43], v[128:131], 0
    ds_read_b64_tr_b16 v[60:61], v12 offset:6432
    ds_read_b64_tr_b16 v[62:63], v12 offset:6816
    s_mov_b32 m0, s96
    s_nop 0
    buffer_load_dwordx4 v7, s[84:87], s38 offen offset:0 sc1 lds
    s_waitcnt lgkmcnt(4)
    v_mfma_f32_32x32x16_bf16 v[64:79], v[44:47], v[132:135], v[64:79]
    ds_read_b64_tr_b16 v[32:33], v12 offset:6464
    ds_read_b64_tr_b16 v[34:35], v12 offset:6848
    s_waitcnt vmcnt(6)
    ds_read_b64_tr_b16 v[136:137], v18 offset:2048
    ds_read_b64_tr_b16 v[138:139], v18 offset:2304
    v_mfma_f32_32x32x16_bf16 v[80:95], v[48:51], v[132:135], v[80:95]
    ds_read_b64_tr_b16 v[36:37], v12 offset:7936
    ds_read_b64_tr_b16 v[38:39], v12 offset:8320
    v_mfma_f32_32x32x16_bf16 v[96:111], v[52:55], v[132:135], v[96:111]
    ds_read_b64_tr_b16 v[40:41], v12 offset:7968
    ds_read_b64_tr_b16 v[42:43], v12 offset:8352
    buffer_load_dwordx4 v7, s[84:87], s38 offen offset:1024 sc1 lds
    s_waitcnt lgkmcnt(4)
    v_mfma_f32_32x32x16_bf16 v[64:79], v[56:59], v[136:139], v[64:79]
    ds_read_b64_tr_b16 v[44:45], v12 offset:8000
    ds_read_b64_tr_b16 v[46:47], v12 offset:8384
    s_waitcnt vmcnt(6)
    ds_read_b64_tr_b16 v[140:141], v18 offset:3072
    ds_read_b64_tr_b16 v[142:143], v18 offset:3328
    v_mfma_f32_32x32x16_bf16 v[80:95], v[60:63], v[136:139], v[80:95]
    ds_read_b64_tr_b16 v[48:49], v12 offset:12800
    ds_read_b64_tr_b16 v[50:51], v12 offset:13184
    v_mfma_f32_32x32x16_bf16 v[96:111], v[32:35], v[136:139], v[96:111]
    ds_read_b64_tr_b16 v[52:53], v12 offset:12832
    ds_read_b64_tr_b16 v[54:55], v12 offset:13216
    buffer_load_dwordx4 v7, s[84:87], s38 offen offset:2048 sc1 lds
    s_waitcnt lgkmcnt(4)
    v_mfma_f32_32x32x16_bf16 v[64:79], v[36:39], v[140:143], v[64:79]
    ds_read_b64_tr_b16 v[56:57], v12 offset:12864
    ds_read_b64_tr_b16 v[58:59], v12 offset:13248
    s_waitcnt vmcnt(6)
    ds_read_b64_tr_b16 v[144:145], v18 offset:4096
    ds_read_b64_tr_b16 v[146:147], v18 offset:4352
    v_mfma_f32_32x32x16_bf16 v[80:95], v[40:43], v[140:143], v[80:95]
    ds_read_b64_tr_b16 v[60:61], v12 offset:14336
    ds_read_b64_tr_b16 v[62:63], v12 offset:14720
    v_mfma_f32_32x32x16_bf16 v[96:111], v[44:47], v[140:143], v[96:111]
    ds_read_b64_tr_b16 v[32:33], v12 offset:14368
    ds_read_b64_tr_b16 v[34:35], v12 offset:14752
    buffer_load_dwordx4 v7, s[84:87], s38 offen offset:3072 sc1 lds
    s_waitcnt lgkmcnt(4)
    v_mfma_f32_32x32x16_bf16 v[64:79], v[48:51], v[144:147], v[64:79]
    ds_read_b64_tr_b16 v[36:37], v12 offset:14400
    ds_read_b64_tr_b16 v[38:39], v12 offset:14784
    s_waitcnt vmcnt(6)
    ds_read_b64_tr_b16 v[148:149], v18 offset:5120
    ds_read_b64_tr_b16 v[150:151], v18 offset:5376
    v_mfma_f32_32x32x16_bf16 v[80:95], v[52:55], v[144:147], v[80:95]
    ds_read_b64_tr_b16 v[40:41], v12 offset:19200
    ds_read_b64_tr_b16 v[42:43], v12 offset:19584
    v_mfma_f32_32x32x16_bf16 v[96:111], v[56:59], v[144:147], v[96:111]
    ds_read_b64_tr_b16 v[44:45], v12 offset:19232
    ds_read_b64_tr_b16 v[46:47], v12 offset:19616
    s_mov_b32 m0, s97
    s_nop 0
    buffer_load_dwordx4 v7, s[84:87], s39 offen offset:0 sc1 lds
    s_waitcnt lgkmcnt(4)
    v_mfma_f32_32x32x16_bf16 v[64:79], v[60:63], v[148:151], v[64:79]
    ds_read_b64_tr_b16 v[48:49], v12 offset:19264
    ds_read_b64_tr_b16 v[50:51], v12 offset:19648
    s_waitcnt vmcnt(6)
    ds_read_b64_tr_b16 v[152:153], v18 offset:6144
    ds_read_b64_tr_b16 v[154:155], v18 offset:6400
    v_mfma_f32_32x32x16_bf16 v[80:95], v[32:35], v[148:151], v[80:95]
    ds_read_b64_tr_b16 v[52:53], v12 offset:20736
    ds_read_b64_tr_b16 v[54:55], v12 offset:21120
    v_mfma_f32_32x32x16_bf16 v[96:111], v[36:39], v[148:151], v[96:111]
    ds_read_b64_tr_b16 v[56:57], v12 offset:20768
    ds_read_b64_tr_b16 v[58:59], v12 offset:21152
    buffer_load_dwordx4 v7, s[84:87], s39 offen offset:1024 sc1 lds
    s_waitcnt lgkmcnt(4)
    v_mfma_f32_32x32x16_bf16 v[64:79], v[40:43], v[152:155], v[64:79]
    ds_read_b64_tr_b16 v[60:61], v12 offset:20800
    ds_read_b64_tr_b16 v[62:63], v12 offset:21184
    s_waitcnt vmcnt(6)
    ds_read_b64_tr_b16 v[156:157], v18 offset:7168
    ds_read_b64_tr_b16 v[158:159], v18 offset:7424
    v_mfma_f32_32x32x16_bf16 v[80:95], v[44:47], v[152:155], v[80:95]
    ds_read_b64_tr_b16 v[32:33], v12 offset:25600
    ds_read_b64_tr_b16 v[34:35], v12 offset:25984
    v_mfma_f32_32x32x16_bf16 v[96:111], v[48:51], v[152:155], v[96:111]
    ds_read_b64_tr_b16 v[36:37], v12 offset:25632
    ds_read_b64_tr_b16 v[38:39], v12 offset:26016
    buffer_load_dwordx4 v7, s[84:87], s39 offen offset:2048 sc1 lds
    s_waitcnt lgkmcnt(4)
    v_mfma_f32_32x32x16_bf16 v[64:79], v[52:55], v[156:159], v[64:79]
    ds_read_b64_tr_b16 v[40:41], v12 offset:25664
    ds_read_b64_tr_b16 v[42:43], v12 offset:26048
    s_waitcnt vmcnt(6)
    ds_read_b64_tr_b16 v[160:161], v18 offset:0
    ds_read_b64_tr_b16 v[162:163], v18 offset:256
    v_mfma_f32_32x32x16_bf16 v[80:95], v[56:59], v[156:159], v[80:95]
    ds_read_b64_tr_b16 v[44:45], v12 offset:27136
    ds_read_b64_tr_b16 v[46:47], v12 offset:27520
    v_mfma_f32_32x32x16_bf16 v[96:111], v[60:63], v[156:159], v[96:111]
    ds_read_b64_tr_b16 v[48:49], v12 offset:27168
    ds_read_b64_tr_b16 v[50:51], v12 offset:27552
    buffer_load_dwordx4 v7, s[84:87], s39 offen offset:3072 sc1 lds
    s_waitcnt lgkmcnt(4)
    v_mfma_f32_32x32x16_bf16 v[64:79], v[32:35], v[160:163], v[64:79]
    ds_read_b64_tr_b16 v[52:53], v12 offset:27200
    ds_read_b64_tr_b16 v[54:55], v12 offset:27584
    s_waitcnt vmcnt(6)
    ds_read_b64_tr_b16 v[164:165], v18 offset:1024
    ds_read_b64_tr_b16 v[166:167], v18 offset:1280
    v_mfma_f32_32x32x16_bf16 v[80:95], v[36:39], v[160:163], v[80:95]
    ds_read_b64_tr_b16 v[56:57], v12 offset:32000
    ds_read_b64_tr_b16 v[58:59], v12 offset:32384
    v_mfma_f32_32x32x16_bf16 v[96:111], v[40:43], v[160:163], v[96:111]
    ds_read_b64_tr_b16 v[60:61], v12 offset:32032
    ds_read_b64_tr_b16 v[62:63], v12 offset:32416
    s_mov_b32 m0, s96
    s_nop 0
    buffer_load_dwordx4 v7, s[84:87], s40 offen offset:0 sc1 lds
    s_waitcnt lgkmcnt(4)
    v_mfma_f32_32x32x16_bf16 v[64:79], v[44:47], v[164:167], v[64:79]
    ds_read_b64_tr_b16 v[32:33], v12 offset:32064
    ds_read_b64_tr_b16 v[34:35], v12 offset:32448
    s_waitcnt vmcnt(6)
    ds_read_b64_tr_b16 v[168:169], v18 offset:2048
    ds_read_b64_tr_b16 v[170:171], v18 offset:2304
    v_mfma_f32_32x32x16_bf16 v[80:95], v[48:51], v[164:167], v[80:95]
    ds_read_b64_tr_b16 v[36:37], v12 offset:33536
    ds_read_b64_tr_b16 v[38:39], v12 offset:33920
    v_mfma_f32_32x32x16_bf16 v[96:111], v[52:55], v[164:167], v[96:111]
    ds_read_b64_tr_b16 v[40:41], v12 offset:33568
    ds_read_b64_tr_b16 v[42:43], v12 offset:33952
    buffer_load_dwordx4 v7, s[84:87], s40 offen offset:1024 sc1 lds
    s_waitcnt lgkmcnt(4)
    v_mfma_f32_32x32x16_bf16 v[64:79], v[56:59], v[168:171], v[64:79]
    ds_read_b64_tr_b16 v[44:45], v12 offset:33600
    ds_read_b64_tr_b16 v[46:47], v12 offset:33984
    s_waitcnt vmcnt(6)
    ds_read_b64_tr_b16 v[172:173], v18 offset:3072
    ds_read_b64_tr_b16 v[174:175], v18 offset:3328
    v_mfma_f32_32x32x16_bf16 v[80:95], v[60:63], v[168:171], v[80:95]
    ds_read_b64_tr_b16 v[48:49], v12 offset:38400
    ds_read_b64_tr_b16 v[50:51], v12 offset:38784
    v_mfma_f32_32x32x16_bf16 v[96:111], v[32:35], v[168:171], v[96:111]
    ds_read_b64_tr_b16 v[52:53], v12 offset:38432
    ds_read_b64_tr_b16 v[54:55], v12 offset:38816
    buffer_load_dwordx4 v7, s[84:87], s40 offen offset:2048 sc1 lds
    s_waitcnt lgkmcnt(4)
    v_mfma_f32_32x32x16_bf16 v[64:79], v[36:39], v[172:175], v[64:79]
    ds_read_b64_tr_b16 v[56:57], v12 offset:38464
    ds_read_b64_tr_b16 v[58:59], v12 offset:38848
    s_waitcnt vmcnt(6)
    ds_read_b64_tr_b16 v[176:177], v18 offset:4096
    ds_read_b64_tr_b16 v[178:179], v18 offset:4352
    v_mfma_f32_32x32x16_bf16 v[80:95], v[40:43], v[172:175], v[80:95]
    ds_read_b64_tr_b16 v[60:61], v12 offset:39936
    ds_read_b64_tr_b16 v[62:63], v12 offset:40320
    v_mfma_f32_32x32x16_bf16 v[96:111], v[44:47], v[172:175], v[96:111]
    ds_read_b64_tr_b16 v[32:33], v12 offset:39968
    ds_read_b64_tr_b16 v[34:35], v12 offset:40352
    buffer_load_dwordx4 v7, s[84:87], s40 offen offset:3072 sc1 lds
    s_waitcnt lgkmcnt(4)
    v_mfma_f32_32x32x16_bf16 v[64:79], v[48:51], v[176:179], v[64:79]
    ds_read_b64_tr_b16 v[36:37], v12 offset:40000
    ds_read_b64_tr_b16 v[38:39], v12 offset:40384
    s_waitcnt vmcnt(6)
    ds_read_b64_tr_b16 v[180:181], v18 offset:5120
    ds_read_b64_tr_b16 v[182:183], v18 offset:5376
    v_mfma_f32_32x32x16_bf16 v[80:95], v[52:55], v[176:179], v[80:95]
    ds_read_b64_tr_b16 v[40:41], v12 offset:44800
    ds_read_b64_tr_b16 v[42:43], v12 offset:45184
    v_mfma_f32_32x32x16_bf16 v[96:111], v[56:59], v[176:179], v[96:111]
    ds_read_b64_tr_b16 v[44:45], v12 offset:44832
    ds_read_b64_tr_b16 v[46:47], v12 offset:45216
    s_mov_b32 m0, s97
    s_nop 0
    buffer_load_dwordx4 v7, s[84:87], s41 offen offset:0 sc1 lds
    s_waitcnt lgkmcnt(4)
    v_mfma_f32_32x32x16_bf16 v[64:79], v[60:63], v[180:183], v[64:79]
    ds_read_b64_tr_b16 v[48:49], v12 offset:44864
    ds_read_b64_tr_b16 v[50:51], v12 offset:45248
    s_waitcnt vmcnt(6)
    ds_read_b64_tr_b16 v[184:185], v18 offset:6144
    ds_read_b64_tr_b16 v[186:187], v18 offset:6400
    v_mfma_f32_32x32x16_bf16 v[80:95], v[32:35], v[180:183], v[80:95]
    ds_read_b64_tr_b16 v[52:53], v12 offset:46336
    ds_read_b64_tr_b16 v[54:55], v12 offset:46720
    v_mfma_f32_32x32x16_bf16 v[96:111], v[36:39], v[180:183], v[96:111]
    ds_read_b64_tr_b16 v[56:57], v12 offset:46368
    ds_read_b64_tr_b16 v[58:59], v12 offset:46752
    buffer_load_dwordx4 v7, s[84:87], s41 offen offset:1024 sc1 lds
    s_waitcnt lgkmcnt(4)
    v_mfma_f32_32x32x16_bf16 v[64:79], v[40:43], v[184:187], v[64:79]
    ds_read_b64_tr_b16 v[60:61], v12 offset:46400
    ds_read_b64_tr_b16 v[62:63], v12 offset:46784
    s_waitcnt vmcnt(6)
    ds_read_b64_tr_b16 v[188:189], v18 offset:7168
    ds_read_b64_tr_b16 v[190:191], v18 offset:7424
    v_mfma_f32_32x32x16_bf16 v[80:95], v[44:47], v[184:187], v[80:95]
    ds_read_b64_tr_b16 v[32:33], v12 offset:51200
    ds_read_b64_tr_b16 v[34:35], v12 offset:51584
    v_mfma_f32_32x32x16_bf16 v[96:111], v[48:51], v[184:187], v[96:111]
    ds_read_b64_tr_b16 v[36:37], v12 offset:51232
    ds_read_b64_tr_b16 v[38:39], v12 offset:51616
    buffer_load_dwordx4 v7, s[84:87], s41 offen offset:2048 sc1 lds
    s_waitcnt lgkmcnt(4)
    v_mfma_f32_32x32x16_bf16 v[64:79], v[52:55], v[188:191], v[64:79]
    ds_read_b64_tr_b16 v[40:41], v12 offset:51264
    ds_read_b64_tr_b16 v[42:43], v12 offset:51648
    s_waitcnt vmcnt(6)
    ds_read_b64_tr_b16 v[192:193], v18 offset:0
    ds_read_b64_tr_b16 v[194:195], v18 offset:256
    v_mfma_f32_32x32x16_bf16 v[80:95], v[56:59], v[188:191], v[80:95]
    ds_read_b64_tr_b16 v[44:45], v12 offset:52736
    ds_read_b64_tr_b16 v[46:47], v12 offset:53120
    v_mfma_f32_32x32x16_bf16 v[96:111], v[60:63], v[188:191], v[96:111]
    ds_read_b64_tr_b16 v[48:49], v12 offset:52768
    ds_read_b64_tr_b16 v[50:51], v12 offset:53152
    buffer_load_dwordx4 v7, s[84:87], s41 offen offset:3072 sc1 lds
    s_waitcnt lgkmcnt(4)
    v_mfma_f32_32x32x16_bf16 v[64:79], v[32:35], v[192:195], v[64:79]
    ds_read_b64_tr_b16 v[52:53], v12 offset:52800
    ds_read_b64_tr_b16 v[54:55], v12 offset:53184
    s_waitcnt vmcnt(6)
    ds_read_b64_tr_b16 v[196:197], v18 offset:1024
    ds_read_b64_tr_b16 v[198:199], v18 offset:1280
    v_mfma_f32_32x32x16_bf16 v[80:95], v[36:39], v[192:195], v[80:95]
    ds_read_b64_tr_b16 v[56:57], v12 offset:57600
    ds_read_b64_tr_b16 v[58:59], v12 offset:57984
    v_mfma_f32_32x32x16_bf16 v[96:111], v[40:43], v[192:195], v[96:111]
    ds_read_b64_tr_b16 v[60:61], v12 offset:57632
    ds_read_b64_tr_b16 v[62:63], v12 offset:58016
    s_mov_b32 m0, s96
    s_nop 0
    buffer_load_dwordx4 v7, s[84:87], s42 offen offset:0 sc1 lds
    s_waitcnt lgkmcnt(4)
    v_mfma_f32_32x32x16_bf16 v[64:79], v[44:47], v[196:199], v[64:79]
    ds_read_b64_tr_b16 v[32:33], v12 offset:57664
    ds_read_b64_tr_b16 v[34:35], v12 offset:58048
    s_waitcnt vmcnt(6)
    ds_read_b64_tr_b16 v[200:201], v18 offset:2048
    ds_read_b64_tr_b16 v[202:203], v18 offset:2304
    v_mfma_f32_32x32x16_bf16 v[80:95], v[48:51], v[196:199], v[80:95]
    ds_read_b64_tr_b16 v[36:37], v12 offset:59136
    ds_read_b64_tr_b16 v[38:39], v12 offset:59520
    v_mfma_f32_32x32x16_bf16 v[96:111], v[52:55], v[196:199], v[96:111]
    ds_read_b64_tr_b16 v[40:41], v12 offset:59168
    ds_read_b64_tr_b16 v[42:43], v12 offset:59552
    buffer_load_dwordx4 v7, s[84:87], s42 offen offset:1024 sc1 lds
    s_waitcnt lgkmcnt(4)
    v_mfma_f32_32x32x16_bf16 v[64:79], v[56:59], v[200:203], v[64:79]
    ds_read_b64_tr_b16 v[44:45], v12 offset:59200
    ds_read_b64_tr_b16 v[46:47], v12 offset:59584
    s_waitcnt vmcnt(6)
    ds_read_b64_tr_b16 v[204:205], v18 offset:3072
    ds_read_b64_tr_b16 v[206:207], v18 offset:3328
    v_mfma_f32_32x32x16_bf16 v[80:95], v[60:63], v[200:203], v[80:95]
    ds_read_b64_tr_b16 v[48:49], v12 offset:64000
    ds_read_b64_tr_b16 v[50:51], v12 offset:64384
    v_mfma_f32_32x32x16_bf16 v[96:111], v[32:35], v[200:203], v[96:111]
    ds_read_b64_tr_b16 v[52:53], v12 offset:64032
    ds_read_b64_tr_b16 v[54:55], v12 offset:64416
    buffer_load_dwordx4 v7, s[84:87], s42 offen offset:2048 sc1 lds
    s_waitcnt lgkmcnt(4)
    v_mfma_f32_32x32x16_bf16 v[64:79], v[36:39], v[204:207], v[64:79]
    ds_read_b64_tr_b16 v[56:57], v12 offset:64064
    ds_read_b64_tr_b16 v[58:59], v12 offset:64448
    s_waitcnt vmcnt(6)
    ds_read_b64_tr_b16 v[208:209], v18 offset:4096
    ds_read_b64_tr_b16 v[210:211], v18 offset:4352
    v_mfma_f32_32x32x16_bf16 v[80:95], v[40:43], v[204:207], v[80:95]
    ds_read_b64_tr_b16 v[60:61], v13 offset:0
    ds_read_b64_tr_b16 v[62:63], v13 offset:384
    v_mfma_f32_32x32x16_bf16 v[96:111], v[44:47], v[204:207], v[96:111]
    ds_read_b64_tr_b16 v[32:33], v13 offset:32
    ds_read_b64_tr_b16 v[34:35], v13 offset:416
    buffer_load_dwordx4 v7, s[84:87], s42 offen offset:3072 sc1 lds
    s_waitcnt lgkmcnt(4)
    v_mfma_f32_32x32x16_bf16 v[64:79], v[48:51], v[208:211], v[64:79]
    ds_read_b64_tr_b16 v[36:37], v13 offset:64
    ds_read_b64_tr_b16 v[38:39], v13 offset:448
    s_waitcnt vmcnt(6)
    ds_read_b64_tr_b16 v[212:213], v18 offset:5120
    ds_read_b64_tr_b16 v[214:215], v18 offset:5376
    v_mfma_f32_32x32x16_bf16 v[80:95], v[52:55], v[208:211], v[80:95]
    ds_read_b64_tr_b16 v[40:41], v13 offset:4864
    ds_read_b64_tr_b16 v[42:43], v13 offset:5248
    v_mfma_f32_32x32x16_bf16 v[96:111], v[56:59], v[208:211], v[96:111]
    ds_read_b64_tr_b16 v[44:45], v13 offset:4896
    ds_read_b64_tr_b16 v[46:47], v13 offset:5280
    s_mov_b32 m0, s97
    s_nop 0
    buffer_load_dwordx4 v7, s[84:87], s43 offen offset:0 sc1 lds
    s_waitcnt lgkmcnt(4)
    v_mfma_f32_32x32x16_bf16 v[64:79], v[60:63], v[212:215], v[64:79]
    ds_read_b64_tr_b16 v[48:49], v13 offset:4928
    ds_read_b64_tr_b16 v[50:51], v13 offset:5312
    s_waitcnt vmcnt(6)
    ds_read_b64_tr_b16 v[216:217], v18 offset:6144
    ds_read_b64_tr_b16 v[218:219], v18 offset:6400
    v_mfma_f32_32x32x16_bf16 v[80:95], v[32:35], v[212:215], v[80:95]
    ds_read_b64_tr_b16 v[52:53], v13 offset:6400
    ds_read_b64_tr_b16 v[54:55], v13 offset:6784
    v_mfma_f32_32x32x16_bf16 v[96:111], v[36:39], v[212:215], v[96:111]
    ds_read_b64_tr_b16 v[56:57], v13 offset:6432
    ds_read_b64_tr_b16 v[58:59], v13 offset:6816
    buffer_load_dwordx4 v7, s[84:87], s43 offen offset:1024 sc1 lds
    s_waitcnt lgkmcnt(4)
    v_mfma_f32_32x32x16_bf16 v[64:79], v[40:43], v[216:219], v[64:79]
    ds_read_b64_tr_b16 v[60:61], v13 offset:6464
    ds_read_b64_tr_b16 v[62:63], v13 offset:6848
    s_waitcnt vmcnt(6)
    ds_read_b64_tr_b16 v[220:221], v18 offset:7168
    ds_read_b64_tr_b16 v[222:223], v18 offset:7424
    v_mfma_f32_32x32x16_bf16 v[80:95], v[44:47], v[216:219], v[80:95]
    ds_read_b64_tr_b16 v[32:33], v13 offset:11264
    ds_read_b64_tr_b16 v[34:35], v13 offset:11648
    v_mfma_f32_32x32x16_bf16 v[96:111], v[48:51], v[216:219], v[96:111]
    ds_read_b64_tr_b16 v[36:37], v13 offset:11296
    ds_read_b64_tr_b16 v[38:39], v13 offset:11680
    buffer_load_dwordx4 v7, s[84:87], s43 offen offset:2048 sc1 lds
    s_waitcnt lgkmcnt(4)
    v_mfma_f32_32x32x16_bf16 v[64:79], v[52:55], v[220:223], v[64:79]
    ds_read_b64_tr_b16 v[40:41], v13 offset:11328
    ds_read_b64_tr_b16 v[42:43], v13 offset:11712
    s_waitcnt vmcnt(6)
    ds_read_b64_tr_b16 v[224:225], v18 offset:0
    ds_read_b64_tr_b16 v[226:227], v18 offset:256
    v_mfma_f32_32x32x16_bf16 v[80:95], v[56:59], v[220:223], v[80:95]
    ds_read_b64_tr_b16 v[44:45], v13 offset:12800
    ds_read_b64_tr_b16 v[46:47], v13 offset:13184
    v_mfma_f32_32x32x16_bf16 v[96:111], v[60:63], v[220:223], v[96:111]
    ds_read_b64_tr_b16 v[48:49], v13 offset:12832
    ds_read_b64_tr_b16 v[50:51], v13 offset:13216
    buffer_load_dwordx4 v7, s[84:87], s43 offen offset:3072 sc1 lds
    s_waitcnt lgkmcnt(4)
    v_mfma_f32_32x32x16_bf16 v[64:79], v[32:35], v[224:227], v[64:79]
    ds_read_b64_tr_b16 v[52:53], v13 offset:12864
    ds_read_b64_tr_b16 v[54:55], v13 offset:13248
    s_waitcnt vmcnt(6)
    ds_read_b64_tr_b16 v[228:229], v18 offset:1024
    ds_read_b64_tr_b16 v[230:231], v18 offset:1280
    s_mov_b64 exec, 1
    ds_add_u32 v14, v15 offset:0
    s_mov_b64 exec, -1
    v_mfma_f32_32x32x16_bf16 v[80:95], v[36:39], v[224:227], v[80:95]
    ds_read_b64_tr_b16 v[56:57], v13 offset:17664
    ds_read_b64_tr_b16 v[58:59], v13 offset:18048
    v_mfma_f32_32x32x16_bf16 v[96:111], v[40:43], v[224:227], v[96:111]
    ds_read_b64_tr_b16 v[60:61], v13 offset:17696
    ds_read_b64_tr_b16 v[62:63], v13 offset:18080
    s_waitcnt lgkmcnt(5)
    v_mfma_f32_32x32x16_bf16 v[64:79], v[44:47], v[228:231], v[64:79]
    ds_read_b64_tr_b16 v[32:33], v13 offset:17728
    ds_read_b64_tr_b16 v[34:35], v13 offset:18112
    s_waitcnt vmcnt(5)
    ds_read_b64_tr_b16 v[232:233], v18 offset:2048
    ds_read_b64_tr_b16 v[234:235], v18 offset:2304
    v_mfma_f32_32x32x16_bf16 v[80:95], v[48:51], v[228:231], v[80:95]
    ds_read_b64_tr_b16 v[36:37], v13 offset:19200
    ds_read_b64_tr_b16 v[38:39], v13 offset:19584
    v_mfma_f32_32x32x16_bf16 v[96:111], v[52:55], v[228:231], v[96:111]
    ds_read_b64_tr_b16 v[40:41], v13 offset:19232
    ds_read_b64_tr_b16 v[42:43], v13 offset:19616
    s_waitcnt lgkmcnt(4)
    v_mfma_f32_32x32x16_bf16 v[64:79], v[56:59], v[232:235], v[64:79]
    ds_read_b64_tr_b16 v[44:45], v13 offset:19264
    ds_read_b64_tr_b16 v[46:47], v13 offset:19648
    s_waitcnt vmcnt(4)
    ds_read_b64_tr_b16 v[236:237], v18 offset:3072
    ds_read_b64_tr_b16 v[238:239], v18 offset:3328
    v_mfma_f32_32x32x16_bf16 v[80:95], v[60:63], v[232:235], v[80:95]
    ds_read_b64_tr_b16 v[48:49], v13 offset:24064
    ds_read_b64_tr_b16 v[50:51], v13 offset:24448
    v_mfma_f32_32x32x16_bf16 v[96:111], v[32:35], v[232:235], v[96:111]
    ds_read_b64_tr_b16 v[52:53], v13 offset:24096
    ds_read_b64_tr_b16 v[54:55], v13 offset:24480
    s_waitcnt lgkmcnt(4)
    v_mfma_f32_32x32x16_bf16 v[64:79], v[36:39], v[236:239], v[64:79]
    ds_read_b64_tr_b16 v[56:57], v13 offset:24128
    ds_read_b64_tr_b16 v[58:59], v13 offset:24512
    s_waitcnt vmcnt(3)
    ds_read_b64_tr_b16 v[240:241], v18 offset:4096
    ds_read_b64_tr_b16 v[242:243], v18 offset:4352
    v_mfma_f32_32x32x16_bf16 v[80:95], v[40:43], v[236:239], v[80:95]
    ds_read_b64_tr_b16 v[60:61], v13 offset:25600
    ds_read_b64_tr_b16 v[62:63], v13 offset:25984
    v_mfma_f32_32x32x16_bf16 v[96:111], v[44:47], v[236:239], v[96:111]
    ds_read_b64_tr_b16 v[32:33], v13 offset:25632
    ds_read_b64_tr_b16 v[34:35], v13 offset:26016
    s_waitcnt lgkmcnt(4)
    v_mfma_f32_32x32x16_bf16 v[64:79], v[48:51], v[240:243], v[64:79]
    ds_read_b64_tr_b16 v[36:37], v13 offset:25664
    ds_read_b64_tr_b16 v[38:39], v13 offset:26048
    s_waitcnt vmcnt(2)
    ds_read_b64_tr_b16 v[244:245], v18 offset:5120
    ds_read_b64_tr_b16 v[246:247], v18 offset:5376
    v_mfma_f32_32x32x16_bf16 v[80:95], v[52:55], v[240:243], v[80:95]
    ds_read_b64_tr_b16 v[40:41], v13 offset:30464
    ds_read_b64_tr_b16 v[42:43], v13 offset:30848
    v_mfma_f32_32x32x16_bf16 v[96:111], v[56:59], v[240:243], v[96:111]
    ds_read_b64_tr_b16 v[44:45], v13 offset:30496
    ds_read_b64_tr_b16 v[46:47], v13 offset:30880
    ds_read_b32 v4, v14 offset:12
    s_waitcnt lgkmcnt(5)
    v_mfma_f32_32x32x16_bf16 v[64:79], v[60:63], v[244:247], v[64:79]
    ds_read_b64_tr_b16 v[48:49], v13 offset:30528
    ds_read_b64_tr_b16 v[50:51], v13 offset:30912
    s_waitcnt vmcnt(1)
    ds_read_b64_tr_b16 v[248:249], v18 offset:6144
    ds_read_b64_tr_b16 v[250:251], v18 offset:6400
    v_mfma_f32_32x32x16_bf16 v[80:95], v[32:35], v[244:247], v[80:95]
    ds_read_b64_tr_b16 v[52:53], v13 offset:32000
    ds_read_b64_tr_b16 v[54:55], v13 offset:32384
    v_mfma_f32_32x32x16_bf16 v[96:111], v[36:39], v[244:247], v[96:111]
    ds_read_b64_tr_b16 v[56:57], v13 offset:32032
    ds_read_b64_tr_b16 v[58:59], v13 offset:32416
    s_waitcnt lgkmcnt(4)
    v_mfma_f32_32x32x16_bf16 v[64:79], v[40:43], v[248:251], v[64:79]
    ds_read_b64_tr_b16 v[60:61], v13 offset:32064
    ds_read_b64_tr_b16 v[62:63], v13 offset:32448
    s_waitcnt vmcnt(0)
    ds_read_b64_tr_b16 v[252:253], v18 offset:7168
    ds_read_b64_tr_b16 v[254:255], v18 offset:7424
    v_cmp_ne_u32 vcc, 4, v4
    s_cbranch_vccz L_ok_19
    s_mov_b32 s98, 0
L_gs_20:
    ds_read_b32 v4, v14 offset:12
    s_add_u32 s98, s98, 1
    s_waitcnt lgkmcnt(0)
    v_cmp_ne_u32 vcc, 4, v4
    s_cbranch_vccz L_gd_21
    s_sleep 1
    s_cmp_lt_u32 s98, 0x1000000
    s_cbranch_scc1 L_gs_20
L_gd_21:
L_ok_19:
    v_mfma_f32_32x32x16_bf16 v[80:95], v[44:47], v[248:251], v[80:95]
    ds_read_b128 v[32:35], v16 offset:40960
    v_mfma_f32_32x32x16_bf16 v[96:111], v[48:51], v[248:251], v[96:111]
    ds_read_b128 v[36:39], v16 offset:41984
    s_waitcnt lgkmcnt(2)
    v_mfma_f32_32x32x16_bf16 v[64:79], v[52:55], v[252:255], v[64:79]
    ds_read_b128 v[40:43], v16 offset:43008
    v_mfma_f32_32x32x16_bf16 v[80:95], v[56:59], v[252:255], v[80:95]
    ds_read_b128 v[44:47], v16 offset:44032
    v_mfma_f32_32x32x16_bf16 v[96:111], v[60:63], v[252:255], v[96:111]
    ds_read_b128 v[48:51], v16 offset:45056
    s_waitcnt lgkmcnt(3)
    v_mfma_f32_32x32x16_bf16 v[112:127], v[32:35], v[128:131], 0
    ds_read_b128 v[52:55], v16 offset:46080
    s_mov_b64 exec, 1
    ds_add_u32 v14, v15 offset:4
    s_mov_b64 exec, -1
    v_mfma_f32_32x32x16_bf16 v[112:127], v[36:39], v[132:135], v[112:127]
    ds_read_b128 v[56:59], v16 offset:47104
    ds_write_b128 v19, v[64:67] offset:0
    s_waitcnt lgkmcnt(5)
    v_mfma_f32_32x32x16_bf16 v[112:127], v[40:43], v[136:139], v[112:127]
    ds_read_b128 v[60:63], v16 offset:48128
    v_mfma_f32_32x32x16_bf16 v[112:127], v[44:47], v[140:143], v[112:127]
    ds_read_b128 v[32:35], v16 offset:49152
    s_waitcnt lgkmcnt(5)
    v_mfma_f32_32x32x16_bf16 v[112:127], v[48:51], v[144:147], v[112:127]
    ds_read_b128 v[36:39], v16 offset:50176
    ds_write_b128 v19, v[68:71] offset:1024
    v_mfma_f32_32x32x16_bf16 v[112:127], v[52:55], v[148:151], v[112:127]
    ds_read_b128 v[40:43], v16 offset:51200
    s_waitcnt lgkmcnt(4)
    v_mfma_f32_32x32x16_bf16 v[112:127], v[56:59], v[152:155], v[112:127]
    ds_read_b128 v[44:47], v16 offset:52224
    v_mfma_f32_32x32x16_bf16 v[112:127], v[60:63], v[156:159], v[112:127]
    ds_read_b128 v[48:51], v16 offset:53248
    ds_write_b128 v19, v[72:75] offset:2048
    s_waitcnt lgkmcnt(5)
    v_mfma_f32_32x32x16_bf16 v[112:127], v[32:35], v[160:163], v[112:127]
    ds_read_b128 v[52:55], v16 offset:54272
    ds_read_b32 v4, v14 offset:4
    v_mfma_f32_32x32x16_bf16 v[112:127], v[36:39], v[164:167], v[112:127]
    ds_read_b128 v[56:59], v16 offset:55296
    s_waitcnt lgkmcnt(5)
    v_mfma_f32_32x32x16_bf16 v[112:127], v[40:43], v[168:171], v[112:127]
    ds_read_b128 v[60:63], v16 offset:56320
    ds_write_b128 v19, v[76:79] offset:3072
    v_mfma_f32_32x32x16_bf16 v[112:127], v[44:47], v[172:175], v[112:127]
    ds_read_b128 v[32:35], v16 offset:57344
    s_waitcnt lgkmcnt(5)
    v_mfma_f32_32x32x16_bf16 v[112:127], v[48:51], v[176:179], v[112:127]
    ds_read_b128 v[36:39], v16 offset:58368
    s_mov_b64 exec, 1
    ds_add_u32 v5, v15 offset:32
    s_mov_b64 exec, -1
    s_waitcnt lgkmcnt(6)
    v_cmp_ne_u32 vcc, 4, v4
    s_cbranch_vccz L_ok_22
    s_mov_b32 s98, 0
L_gs_23:
    ds_read_b32 v4, v14 offset:4
    s_add_u32 s98, s98, 1
    s_waitcnt lgkmcnt(0)
    v_cmp_ne_u32 vcc, 4, v4
    s_cbranch_vccz L_gd_24
    s_sleep 1
    s_cmp_lt_u32 s98, 0x1000000
    s_cbranch_scc1 L_gs_23
L_gd_24:
L_ok_22:
    v_mfma_f32_32x32x16_bf16 v[112:127], v[52:55], v[180:183], v[112:127]
    ds_read_b128 v[40:43], v16 offset:59392
    ds_write_b128 v19, v[80:83] offset:4096
    s_waitcnt lgkmcnt(6)
    v_mfma_f32_32x32x16_bf16 v[112:127], v[56:59], v[184:187], v[112:127]
    ds_read_b128 v[44:47], v16 offset:60416
    ds_read_b32 v4, v14 offset:16
    v_mfma_f32_32x32x16_bf16 v[112:127], v[60:63], v[188:191], v[112:127]
    ds_read_b128 v[48:51], v16 offset:61440
    s_waitcnt lgkmcnt(6)
    v_mfma_f32_32x32x16_bf16 v[112:127], v[32:35], v[192:195], v[112:127]
    ds_read_b128 v[52:55], v16 offset:62464
    ds_write_b128 v19, v[84:87] offset:5120
    v_mfma_f32_32x32x16_bf16 v[112:127], v[36:39], v[196:199], v[112:127]
    ds_read_b128 v[56:59], v16 offset:63488
    s_waitcnt lgkmcnt(5)
    v_mfma_f32_32x32x16_bf16 v[112:127], v[40:43], v[200:203], v[112:127]
    ds_read_b128 v[60:63], v16 offset:64512
    s_waitcnt lgkmcnt(5)
    v_cmp_ne_u32 vcc, 4, v4
    s_cbranch_vccz L_ok_25
    s_mov_b32 s98, 0
L_gs_26:
    ds_read_b32 v4, v14 offset:16
    s_add_u32 s98, s98, 1
    s_waitcnt lgkmcnt(0)
    v_cmp_ne_u32 vcc, 4, v4
    s_cbranch_vccz L_gd_27
    s_sleep 1
    s_cmp_lt_u32 s98, 0x1000000
    s_cbranch_scc1 L_gs_26
L_gd_27:
L_ok_25:
    v_mfma_f32_32x32x16_bf16 v[112:127], v[44:47], v[204:207], v[112:127]
    ds_read_b128 v[32:35], v7 offset:0
    ds_write_b128 v19, v[88:91] offset:6144
    s_waitcnt lgkmcnt(5)
    v_mfma_f32_32x32x16_bf16 v[112:127], v[48:51], v[208:211], v[112:127]
    ds_read_b128 v[36:39], v7 offset:1024
    v_mfma_f32_32x32x16_bf16 v[112:127], v[52:55], v[212:215], v[112:127]
    ds_read_b128 v[40:43], v7 offset:2048
    s_waitcnt lgkmcnt(4)
    v_mfma_f32_32x32x16_bf16 v[112:127], v[56:59], v[216:219], v[112:127]
    ds_read_b128 v[44:47], v7 offset:3072
    ds_write_b128 v19, v[92:95] offset:7168
    v_mfma_f32_32x32x16_bf16 v[112:127], v[60:63], v[220:223], v[112:127]
    ds_read_b128 v[48:51], v7 offset:4096
    s_waitcnt lgkmcnt(4)
    v_mfma_f32_32x32x16_bf16 v[112:127], v[32:35], v[224:227], v[112:127]
    ds_read_b128 v[52:55], v7 offset:5120
    s_mov_b64 exec, 1
    ds_add_u32 v5, v15 offset:32
    s_mov_b64 exec, -1
    v_mfma_f32_32x32x16_bf16 v[112:127], v[36:39], v[228:231], v[112:127]
    ds_read_b128 v[56:59], v7 offset:6144
    ds_write_b128 v9, v[96:99] offset:0
    s_waitcnt lgkmcnt(6)
    v_mfma_f32_32x32x16_bf16 v[112:127], v[40:43], v[232:235], v[112:127]
    ds_read_b128 v[60:63], v7 offset:7168
    v_mfma_f32_32x32x16_bf16 v[112:127], v[44:47], v[236:239], v[112:127]
    ds_read_b128 v[32:35], v7 offset:8192
    s_waitcnt lgkmcnt(5)
    v_mfma_f32_32x32x16_bf16 v[112:127], v[48:51], v[240:243], v[112:127]
    ds_read_b128 v[36:39], v7 offset:9216
    ds_write_b128 v9, v[100:103] offset:1024
    v_mfma_f32_32x32x16_bf16 v[112:127], v[52:55], v[244:247], v[112:127]
    ds_read_b128 v[40:43], v7 offset:10240
    s_waitcnt lgkmcnt(4)
    v_mfma_f32_32x32x16_bf16 v[112:127], v[56:59], v[248:251], v[112:127]
    ds_read_b128 v[44:47], v7 offset:11264
    v_mfma_f32_32x32x16_bf16 v[112:127], v[60:63], v[252:255], v[112:127]
    ds_read_b128 v[48:51], v7 offset:12288
    ds_write_b128 v9, v[104:107] offset:2048
    s_waitcnt lgkmcnt(5)
    v_mfma_f32_32x32x16_bf16 v[64:79], v[32:35], v[128:131], 0
    ds_read_b128 v[52:55], v7 offset:13312
    v_mfma_f32_32x32x16_bf16 v[64:79], v[36:39], v[132:135], v[64:79]
    ds_read_b128 v[56:59], v7 offset:14336
    s_waitcnt lgkmcnt(4)
    v_mfma_f32_32x32x16_bf16 v[64:79], v[40:43], v[136:139], v[64:79]
    ds_read_b128 v[60:63], v7 offset:15360
    ds_write_b128 v9, v[108:111] offset:3072
    v_mfma_f32_32x32x16_bf16 v[64:79], v[44:47], v[140:143], v[64:79]
    ds_read_b128 v[32:35], v7 offset:16384
    s_waitcnt lgkmcnt(4)
    v_mfma_f32_32x32x16_bf16 v[64:79], v[48:51], v[144:147], v[64:79]
    ds_read_b128 v[36:39], v7 offset:17408
    s_mov_b64 exec, 1
    ds_add_u32 v5, v15 offset:32
    s_mov_b64 exec, -1
    v_mfma_f32_32x32x16_bf16 v[64:79], v[52:55], v[148:151], v[64:79]
    ds_read_b128 v[40:43], v7 offset:18432
    s_waitcnt lgkmcnt(5)
    v_mfma_f32_32x32x16_bf16 v[64:79], v[56:59], v[152:155], v[64:79]
    ds_read_b128 v[44:47], v7 offset:19456
    v_mfma_f32_32x32x16_bf16 v[64:79], v[60:63], v[156:159], v[64:79]
    ds_read_b128 v[48:51], v7 offset:20480
    s_waitcnt lgkmcnt(4)
    v_mfma_f32_32x32x16_bf16 v[64:79], v[32:35], v[160:163], v[64:79]
    ds_read_b128 v[52:55], v7 offset:21504
    v_mfma_f32_32x32x16_bf16 v[64:79], v[36:39], v[164:167], v[64:79]
    ds_read_b128 v[56:59], v7 offset:22528
    s_waitcnt lgkmcnt(3)
    v_mfma_f32_32x32x16_bf16 v[64:79], v[40:43], v[168:171], v[64:79]
    ds_read_b128 v[60:63], v7 offset:23552
    v_mfma_f32_32x32x16_bf16 v[64:79], v[44:47], v[172:175], v[64:79]
    ds_read_b128 v[32:35], v7 offset:24576
    s_waitcnt lgkmcnt(3)
    v_mfma_f32_32x32x16_bf16 v[64:79], v[48:51], v[176:179], v[64:79]
    ds_read_b128 v[36:39], v7 offset:25600
    v_mfma_f32_32x32x16_bf16 v[64:79], v[52:55], v[180:183], v[64:79]
    ds_read_b128 v[40:43], v7 offset:26624
    s_waitcnt lgkmcnt(3)
    v_mfma_f32_32x32x16_bf16 v[64:79], v[56:59], v[184:187], v[64:79]
    ds_read_b128 v[44:47], v7 offset:27648
    ds_read_b32 v4, v14 offset:28
    v_mfma_f32_32x32x16_bf16 v[64:79], v[60:63], v[188:191], v[64:79]
    ds_read_b128 v[48:51], v7 offset:28672
    s_waitcnt lgkmcnt(4)
    v_mfma_f32_32x32x16_bf16 v[64:79], v[32:35], v[192:195], v[64:79]
    ds_read_b128 v[52:55], v7 offset:29696
    v_mfma_f32_32x32x16_bf16 v[64:79], v[36:39], v[196:199], v[64:79]
    ds_read_b128 v[56:59], v7 offset:30720
    s_waitcnt lgkmcnt(4)
    v_mfma_f32_32x32x16_bf16 v[64:79], v[40:43], v[200:203], v[64:79]
    ds_read_b128 v[60:63], v7 offset:31744
    s_waitcnt lgkmcnt(4)
    v_cmp_ne_u32 vcc, 4, v4
    s_cbranch_vccz L_ok_28
    s_mov_b32 s98, 0
L_gs_29:
    ds_read_b32 v4, v14 offset:28
    s_add_u32 s98, s98, 1
    s_waitcnt lgkmcnt(0)
    v_cmp_ne_u32 vcc, 4, v4
    s_cbranch_vccz L_gd_30
    s_sleep 1
    s_cmp_lt_u32 s98, 0x1000000
    s_cbranch_scc1 L_gs_29
L_gd_30:
L_ok_28:
    v_mfma_f32_32x32x16_bf16 v[64:79], v[44:47], v[204:207], v[64:79]
    ds_read_b128 v[32:35], v7 offset:32768
    s_waitcnt lgkmcnt(3)
    v_mfma_f32_32x32x16_bf16 v[64:79], v[48:51], v[208:211], v[64:79]
    ds_read_b128 v[36:39], v7 offset:33792
    ds_read_b32 v21, v17 offset:0
    ds_read_b32 v22, v17 offset:256
    ds_read_b32 v23, v17 offset:512
    ds_read_b128 v[80:83], v11 offset:384
    ds_read_b128 v[84:87], v11 offset:416
    ds_read_b128 v[88:91], v11 offset:448
    ds_read_b128 v[92:95], v11 offset:480
    v_mfma_f32_32x32x16_bf16 v[64:79], v[52:55], v[212:215], v[64:79]
    ds_read_b128 v[40:43], v7 offset:34816
    s_waitcnt lgkmcnt(10)
    v_mfma_f32_32x32x16_bf16 v[64:79], v[56:59], v[216:219], v[64:79]
    ds_read_b128 v[44:47], v7 offset:35840
    s_cmp_eq_u32 s90, 1
    s_cbranch_scc0 L_if_31
    ds_write_b128 v20, v[128:131] offset:0
    ds_write_b128 v20, v[132:135] offset:1024
    ds_write_b128 v20, v[136:139] offset:2048
    ds_write_b128 v20, v[140:143] offset:3072
L_if_31:
    ds_read_b32 v4, v14 offset:20
    v_mfma_f32_32x32x16_bf16 v[64:79], v[60:63], v[220:223], v[64:79]
    ds_read_b128 v[48:51], v7 offset:36864
    s_waitcnt lgkmcnt(11)
    v_mfma_f32_32x32x16_bf16 v[64:79], v[32:35], v[224:227], v[64:79]
    ds_read_b128 v[52:55], v7 offset:37888
    v_mfma_f32_32x32x16_bf16 v[64:79], v[36:39], v[228:231], v[64:79]
    ds_read_b128 v[56:59], v7 offset:38912
    s_waitcnt lgkmcnt(4)
    v_mfma_f32_32x32x16_bf16 v[64:79], v[40:43], v[232:235], v[64:79]
    ds_read_b128 v[60:63], v7 offset:39936
    s_waitcnt lgkmcnt(4)
    v_cmp_ne_u32 vcc, 4, v4
    s_cbranch_vccz L_ok_32
    s_mov_b32 s98, 0
L_gs_33:
    ds_read_b32 v4, v14 offset:20
    s_add_u32 s98, s98, 1
    s_waitcnt lgkmcnt(0)
    v_cmp_ne_u32 vcc, 4, v4
    s_cbranch_vccz L_gd_34
    s_sleep 1
    s_cmp_lt_u32 s98, 0x1000000
    s_cbranch_scc1 L_gs_33
L_gd_34:
L_ok_32:
    v_mfma_f32_32x32x16_bf16 v[64:79], v[44:47], v[236:239], v[64:79]
    ds_read_b128 v[32:35], v7 offset:40960
    s_waitcnt lgkmcnt(3)
    v_mfma_f32_32x32x16_bf16 v[64:79], v[48:51], v[240:243], v[64:79]
    ds_read_b128 v[36:39], v7 offset:41984
    v_fmac_f32 v112, v21, v80
    v_fmac_f32 v113, v21, v81
    v_fmac_f32 v114, v21, v82
    v_mfma_f32_32x32x16_bf16 v[64:79], v[52:55], v[244:247], v[64:79]
    ds_read_b128 v[40:43], v7 offset:43008
    v_fmac_f32 v115, v21, v83
    v_fmac_f32 v116, v21, v84
    v_fmac_f32 v117, v21, v85
    s_waitcnt lgkmcnt(3)
    v_mfma_f32_32x32x16_bf16 v[64:79], v[56:59], v[248:251], v[64:79]
    ds_read_b128 v[44:47], v7 offset:44032
    v_fmac_f32 v118, v21, v86
    v_fmac_f32 v119, v21, v87
    v_mul_f32 v24, v23, v112
    v_mfma_f32_32x32x16_bf16 v[64:79], v[60:63], v[252:255], v[64:79]
    ds_read_b128 v[48:51], v7 offset:45056
    v_mul_f32 v25, v23, v113
    v_mul_f32 v26, v23, v114
    v_mul_f32 v27, v23, v115
    s_waitcnt lgkmcnt(3)
    v_mfma_f32_32x32x16_bf16 v[96:111], v[32:35], v[128:131], 0
    ds_read_b128 v[52:55], v7 offset:46080
    v_mul_f32 v28, v23, v116
    v_mul_f32 v29, v23, v117
    v_mul_f32 v30, v23, v118
    v_mfma_f32_32x32x16_bf16 v[96:111], v[36:39], v[132:135], v[96:111]
    ds_read_b128 v[56:59], v7 offset:47104
    v_mul_f32 v31, v23, v119
    v_exp_f32 v24, v24
    s_waitcnt lgkmcnt(3)
    v_mfma_f32_32x32x16_bf16 v[96:111], v[40:43], v[136:139], v[96:111]
    ds_read_b128 v[60:63], v7 offset:48128
    s_mov_b64 exec, 1
    ds_add_u32 v14, v15 offset:8
    s_mov_b64 exec, -1
    v_fmac_f32 v120, v21, v88
    v_exp_f32 v25, v25
    v_mfma_f32_32x32x16_bf16 v[96:111], v[44:47], v[140:143], v[96:111]
    ds_read_b128 v[32:35], v7 offset:49152
    v_fmac_f32 v121, v21, v89
    v_exp_f32 v26, v26
    s_waitcnt lgkmcnt(4)
    v_mfma_f32_32x32x16_bf16 v[96:111], v[48:51], v[144:147], v[96:111]
    ds_read_b128 v[36:39], v7 offset:50176
    v_fmac_f32 v122, v21, v90
    v_exp_f32 v27, v27
    v_mfma_f32_32x32x16_bf16 v[96:111], v[52:55], v[148:151], v[96:111]
    ds_read_b128 v[40:43], v7 offset:51200
    v_fmac_f32 v123, v21, v91
    v_exp_f32 v28, v28
    s_waitcnt lgkmcnt(4)
    v_mfma_f32_32x32x16_bf16 v[96:111], v[56:59], v[152:155], v[96:111]
    ds_read_b128 v[44:47], v7 offset:52224
    v_fmac_f32 v124, v21, v92
    v_exp_f32 v29, v29
    v_mfma_f32_32x32x16_bf16 v[96:111], v[60:63], v[156:159], v[96:111]
    ds_read_b128 v[48:51], v7 offset:53248
    v_fmac_f32 v125, v21, v93
    v_exp_f32 v30, v30
    s_waitcnt lgkmcnt(3)
    v_mfma_f32_32x32x16_bf16 v[96:111], v[32:35], v[160:163], v[96:111]
    ds_read_b128 v[52:55], v7 offset:54272
    v_fmac_f32 v126, v21, v94
    v_exp_f32 v31, v31
    v_mfma_f32_32x32x16_bf16 v[96:111], v[36:39], v[164:167], v[96:111]
    ds_read_b128 v[56:59], v7 offset:55296
    v_fmac_f32 v127, v21, v95
    ds_read_b128 v[80:83], v11 offset:512
    ds_read_b128 v[84:87], v11 offset:544
    s_waitcnt lgkmcnt(5)
    v_mfma_f32_32x32x16_bf16 v[96:111], v[40:43], v[168:171], v[96:111]
    ds_read_b128 v[60:63], v7 offset:56320
    ds_read_b128 v[88:91], v11 offset:576
    ds_read_b128 v[92:95], v11 offset:608
    v_fma_f32 v24, v24, v22, v22
    v_mfma_f32_32x32x16_bf16 v[96:111], v[44:47], v[172:175], v[96:111]
    ds_read_b128 v[32:35], v7 offset:57344
    v_fma_f32 v25, v25, v22, v22
    v_fma_f32 v26, v26, v22, v22
    v_fma_f32 v27, v27, v22, v22
    s_waitcnt lgkmcnt(7)
    v_mfma_f32_32x32x16_bf16 v[96:111], v[48:51], v[176:179], v[96:111]
    ds_read_b128 v[36:39], v7 offset:58368
    v_fma_f32 v28, v28, v22, v22
    v_fma_f32 v29, v29, v22, v22
    v_fma_f32 v30, v30, v22, v22
    v_mfma_f32_32x32x16_bf16 v[96:111], v[52:55], v[180:183], v[96:111]
    ds_read_b128 v[40:43], v7 offset:59392
    v_fma_f32 v31, v31, v22, v22
    v_rcp_f32 v24, v24
    s_waitcnt lgkmcnt(5)
    v_mfma_f32_32x32x16_bf16 v[96:111], v[56:59], v[184:187], v[96:111]
    ds_read_b128 v[44:47], v7 offset:60416
    v_mul_f32 v112, v112, v120
    v_rcp_f32 v25, v25
    v_mfma_f32_32x32x16_bf16 v[96:111], v[60:63], v[188:191], v[96:111]
    ds_read_b128 v[48:51], v7 offset:61440
    v_mul_f32 v113, v113, v121
    v_rcp_f32 v26, v26
    s_waitcnt lgkmcnt(3)
    v_mfma_f32_32x32x16_bf16 v[96:111], v[32:35], v[192:195], v[96:111]
    ds_read_b128 v[52:55], v7 offset:62464
    v_mul_f32 v114, v114, v122
    v_rcp_f32 v27, v27
    v_mfma_f32_32x32x16_bf16 v[96:111], v[36:39], v[196:199], v[96:111]
    ds_read_b128 v[56:59], v7 offset:63488
    v_mul_f32 v115, v115, v123
    v_rcp_f32 v28, v28
    s_waitcnt lgkmcnt(3)
    v_mfma_f32_32x32x16_bf16 v[96:111], v[40:43], v[200:203], v[96:111]
    ds_read_b128 v[60:63], v7 offset:64512
    v_mul_f32 v116, v116, v124
    v_rcp_f32 v29, v29
    v_mfma_f32_32x32x16_bf16 v[96:111], v[44:47], v[204:207], v[96:111]
    ds_read_b128 v[32:35], v16 offset:0
    v_mul_f32 v117, v117, v125
    v_rcp_f32 v30, v30
    s_waitcnt lgkmcnt(3)
    v_mfma_f32_32x32x16_bf16 v[96:111], v[48:51], v[208:211], v[96:111]
    ds_read_b128 v[36:39], v16 offset:1024
    v_mul_f32 v118, v118, v126
    v_rcp_f32 v31, v31
    v_mfma_f32_32x32x16_bf16 v[96:111], v[52:55], v[212:215], v[96:111]
    ds_read_b128 v[40:43], v16 offset:2048
    v_mul_f32 v119, v119, v127
    v_mul_f32 v112, v112, v24
    v_mul_f32 v113, v113, v25
    s_waitcnt lgkmcnt(3)
    v_mfma_f32_32x32x16_bf16 v[96:111], v[56:59], v[216:219], v[96:111]
    ds_read_b128 v[44:47], v16 offset:3072
    ds_read_b32 v4, v14 offset:24
    v_mul_f32 v114, v114, v26
    v_mul_f32 v115, v115, v27
    v_mul_f32 v116, v116, v28
    v_mfma_f32_32x32x16_bf16 v[96:111], v[60:63], v[220:223], v[96:111]
    ds_read_b128 v[48:51], v16 offset:4096
    v_mul_f32 v117, v117, v29
    v_mul_f32 v118, v118, v30
    v_mul_f32 v119, v119, v31
    s_waitcnt lgkmcnt(4)
    v_mfma_f32_32x32x16_bf16 v[96:111], v[32:35], v[224:227], v[96:111]
    ds_read_b128 v[52:55], v16 offset:5120
    v_cvt_pk_bf16_f32 v120, v112, v113
    v_cvt_pk_bf16_f32 v121, v114, v115
    v_cvt_pk_bf16_f32 v122, v116, v117
    v_mfma_f32_32x32x16_bf16 v[96:111], v[36:39], v[228:231], v[96:111]
    ds_read_b128 v[56:59], v16 offset:6144
    v_cvt_pk_bf16_f32 v123, v118, v119
    buffer_store_dwordx4 v[120:123], v7, s[84:87], s88 offen offset:0 sc1
    v_fmac_f32 v64, v21, v80
    s_waitcnt lgkmcnt(4)
    v_mfma_f32_32x32x16_bf16 v[96:111], v[40:43], v[232:235], v[96:111]
    ds_read_b128 v[60:63], v16 offset:7168
    s_waitcnt lgkmcnt(4)
    v_cmp_ne_u32 vcc, 4, v4
    s_cbranch_vccz L_ok_35
    s_mov_b32 s98, 0
L_gs_36:
    ds_read_b32 v4, v14 offset:24
    s_add_u32 s98, s98, 1
    s_waitcnt lgkmcnt(0)
    v_cmp_ne_u32 vcc, 4, v4
    s_cbranch_vccz L_gd_37
    s_sleep 1
    s_cmp_lt_u32 s98, 0x1000000
    s_cbranch_scc1 L_gs_36
L_gd_37:
L_ok_35:
    v_fmac_f32 v65, v21, v81
    v_fmac_f32 v66, v21, v82
    v_fmac_f32 v67, v21, v83
    v_mfma_f32_32x32x16_bf16 v[96:111], v[44:47], v[236:239], v[96:111]
    ds_read_b128 v[32:35], v6 offset:0
    v_fmac_f32 v68, v21, v84
    v_fmac_f32 v69, v21, v85
    v_fmac_f32 v70, v21, v86
    s_waitcnt lgkmcnt(3)
    v_mfma_f32_32x32x16_bf16 v[96:111], v[48:51], v[240:243], v[96:111]
    ds_read_b128 v[36:39], v6 offset:1024
    v_fmac_f32 v71, v21, v87
    v_mul_f32 v24, v23, v64
    v_mul_f32 v25, v23, v65
    v_mfma_f32_32x32x16_bf16 v[96:111], v[52:55], v[244:247], v[96:111]
    ds_read_b128 v[40:43], v6 offset:2048
    v_mul_f32 v26, v23, v66
    v_mul_f32 v27, v23, v67
    v_mul_f32 v28, v23, v68
    s_waitcnt lgkmcnt(3)
    v_mfma_f32_32x32x16_bf16 v[96:111], v[56:59], v[248:251], v[96:111]
    ds_read_b128 v[44:47], v6 offset:3072
    v_mul_f32 v29, v23, v69
    v_mul_f32 v30, v23, v70
    v_mul_f32 v31, v23, v71
    v_mfma_f32_32x32x16_bf16 v[96:111], v[60:63], v[252:255], v[96:111]
    ds_read_b128 v[48:51], v6 offset:4096
    v_exp_f32 v24, v24
    v_fmac_f32 v72, v21, v88
    s_waitcnt lgkmcnt(3)
    v_mfma_f32_32x32x16_bf16 v[112:127], v[32:35], v[128:131], 0
    ds_read_b128 v[52:55], v6 offset:5120
    v_exp_f32 v25, v25
    v_fmac_f32 v73, v21, v89
    v_mfma_f32_32x32x16_bf16 v[112:127], v[36:39], v[132:135], v[112:127]
    ds_read_b128 v[56:59], v6 offset:6144
    v_exp_f32 v26, v26
    v_fmac_f32 v74, v21, v90
    s_waitcnt lgkmcnt(3)
    v_mfma_f32_32x32x16_bf16 v[112:127], v[40:43], v[136:139], v[112:127]
    ds_read_b128 v[60:63], v6 offset:7168
    v_exp_f32 v27, v27
    v_fmac_f32 v75, v21, v91
    v_mfma_f32_32x32x16_bf16 v[112:127], v[44:47], v[140:143], v[112:127]
    ds_read_b128 v[32:35], v6 offset:8192
    v_exp_f32 v28, v28
    v_fmac_f32 v76, v21, v92
    s_waitcnt lgkmcnt(3)
    v_mfma_f32_32x32x16_bf16 v[112:127], v[48:51], v[144:147], v[112:127]
    ds_read_b128 v[36:39], v6 offset:9216
    v_exp_f32 v29, v29
    v_fmac_f32 v77, v21, v93
    v_mfma_f32_32x32x16_bf16 v[112:127], v[52:55], v[148:151], v[112:127]
    ds_read_b128 v[40:43], v6 offset:10240
    v_exp_f32 v30, v30
    v_fmac_f32 v78, v21, v94
    s_waitcnt lgkmcnt(3)
    v_mfma_f32_32x32x16_bf16 v[112:127], v[56:59], v[152:155], v[112:127]
    ds_read_b128 v[44:47], v6 offset:11264
    v_exp_f32 v31, v31
    v_fmac_f32 v79, v21, v95
    v_mfma_f32_32x32x16_bf16 v[112:127], v[60:63], v[156:159], v[112:127]
    ds_read_b128 v[48:51], v6 offset:12288
    ds_read_b128 v[80:83], v11 offset:640
    ds_read_b128 v[84:87], v11 offset:672
    ds_read_b128 v[88:91], v11 offset:704
    s_waitcnt lgkmcnt(6)
    v_mfma_f32_32x32x16_bf16 v[112:127], v[32:35], v[160:163], v[112:127]
    ds_read_b128 v[52:55], v6 offset:13312
    ds_read_b128 v[92:95], v11 offset:736
    v_fma_f32 v24, v24, v22, v22
    v_fma_f32 v25, v25, v22, v22
    v_mfma_f32_32x32x16_bf16 v[112:127], v[36:39], v[164:167], v[112:127]
    ds_read_b128 v[56:59], v6 offset:14336
    v_fma_f32 v26, v26, v22, v22
    v_fma_f32 v27, v27, v22, v22
    v_fma_f32 v28, v28, v22, v22
    s_waitcnt lgkmcnt(7)
    v_mfma_f32_32x32x16_bf16 v[112:127], v[40:43], v[168:171], v[112:127]
    ds_read_b128 v[60:63], v6 offset:15360
    v_fma_f32 v29, v29, v22, v22
    v_fma_f32 v30, v30, v22, v22
    v_fma_f32 v31, v31, v22, v22
    v_mfma_f32_32x32x16_bf16 v[112:127], v[44:47], v[172:175], v[112:127]
    ds_read_b128 v[32:35], v6 offset:16384
    v_rcp_f32 v24, v24
    v_mul_f32 v64, v64, v72
    s_waitcnt lgkmcnt(4)
    v_mfma_f32_32x32x16_bf16 v[112:127], v[48:51], v[176:179], v[112:127]
    ds_read_b128 v[36:39], v6 offset:17408
    v_rcp_f32 v25, v25
    v_mul_f32 v65, v65, v73
    v_mfma_f32_32x32x16_bf16 v[112:127], v[52:55], v[180:183], v[112:127]
    ds_read_b128 v[40:43], v6 offset:18432
    v_rcp_f32 v26, v26
    v_mul_f32 v66, v66, v74
    s_waitcnt lgkmcnt(3)
    v_mfma_f32_32x32x16_bf16 v[112:127], v[56:59], v[184:187], v[112:127]
    ds_read_b128 v[44:47], v6 offset:19456
    v_rcp_f32 v27, v27
    v_mul_f32 v67, v67, v75
    v_mfma_f32_32x32x16_bf16 v[112:127], v[60:63], v[188:191], v[112:127]
    ds_read_b128 v[48:51], v6 offset:20480
    v_rcp_f32 v28, v28
    v_mul_f32 v68, v68, v76
    s_waitcnt lgkmcnt(3)
    v_mfma_f32_32x32x16_bf16 v[112:127], v[32:35], v[192:195], v[112:127]
    ds_read_b128 v[52:55], v6 offset:21504
    v_rcp_f32 v29, v29
    v_mul_f32 v69, v69, v77
    v_mfma_f32_32x32x16_bf16 v[112:127], v[36:39], v[196:199], v[112:127]
    ds_read_b128 v[56:59], v6 offset:22528
    v_rcp_f32 v30, v30
    v_mul_f32 v70, v70, v78
    s_waitcnt lgkmcnt(3)
    v_mfma_f32_32x32x16_bf16 v[112:127], v[40:43], v[200:203], v[112:127]
    ds_read_b128 v[60:63], v6 offset:23552
    v_rcp_f32 v31, v31
    v_mul_f32 v71, v71, v79
    v_mfma_f32_32x32x16_bf16 v[112:127], v[44:47], v[204:207], v[112:127]
    ds_read_b128 v[32:35], v6 offset:24576
    v_mul_f32 v64, v64, v24
    v_mul_f32 v65, v65, v25
    v_mul_f32 v66, v66, v26
    s_waitcnt lgkmcnt(3)
    v_mfma_f32_32x32x16_bf16 v[112:127], v[48:51], v[208:211], v[112:127]
    ds_read_b128 v[36:39], v6 offset:25600
    v_mul_f32 v67, v67, v27
    v_mul_f32 v68, v68, v28
    v_mul_f32 v69, v69, v29
    v_mfma_f32_32x32x16_bf16 v[112:127], v[52:55], v[212:215], v[112:127]
    ds_read_b128 v[40:43], v6 offset:26624
    v_mul_f32 v70, v70, v30
    v_mul_f32 v71, v71, v31
    v_cvt_pk_bf16_f32 v72, v64, v65
    s_waitcnt lgkmcnt(3)
    v_mfma_f32_32x32x16_bf16 v[112:127], v[56:59], v[216:219], v[112:127]
    ds_read_b128 v[44:47], v6 offset:27648
    v_cvt_pk_bf16_f32 v73, v66, v67
    v_cvt_pk_bf16_f32 v74, v68, v69
    v_cvt_pk_bf16_f32 v75, v70, v71
    v_mfma_f32_32x32x16_bf16 v[112:127], v[60:63], v[220:223], v[112:127]
    ds_read_b128 v[48:51], v6 offset:28672
    buffer_store_dwordx4 v[72:75], v7, s[84:87], s88 offen offset:1024 sc1
    v_fmac_f32 v96, v21, v80
    v_fmac_f32 v97, v21, v81
    s_waitcnt lgkmcnt(3)
    v_mfma_f32_32x32x16_bf16 v[112:127], v[32:35], v[224:227], v[112:127]
    ds_read_b128 v[52:55], v6 offset:29696
    v_fmac_f32 v98, v21, v82
    v_fmac_f32 v99, v21, v83
    v_fmac_f32 v100, v21, v84
    v_mfma_f32_32x32x16_bf16 v[112:127], v[36:39], v[228:231], v[112:127]
    ds_read_b128 v[56:59], v6 offset:30720
    v_fmac_f32 v101, v21, v85
    v_fmac_f32 v102, v21, v86
    v_fmac_f32 v103, v21, v87
    s_waitcnt lgkmcnt(3)
    v_mfma_f32_32x32x16_bf16 v[112:127], v[40:43], v[232:235], v[112:127]
    ds_read_b128 v[60:63], v6 offset:31744
    v_mul_f32 v24, v23, v96
    v_mul_f32 v25, v23, v97
    v_mul_f32 v26, v23, v98
    v_mfma_f32_32x32x16_bf16 v[112:127], v[44:47], v[236:239], v[112:127]
    v_mul_f32 v27, v23, v99
    v_mul_f32 v28, v23, v100
    v_mul_f32 v29, v23, v101
    s_waitcnt lgkmcnt(2)
    v_mfma_f32_32x32x16_bf16 v[112:127], v[48:51], v[240:243], v[112:127]
    v_mul_f32 v30, v23, v102
    v_mul_f32 v31, v23, v103
    v_exp_f32 v24, v24
    v_mfma_f32_32x32x16_bf16 v[112:127], v[52:55], v[244:247], v[112:127]
    v_fmac_f32 v104, v21, v88
    v_exp_f32 v25, v25
    s_waitcnt lgkmcnt(0)
    v_mfma_f32_32x32x16_bf16 v[112:127], v[56:59], v[248:251], v[112:127]
    v_fmac_f32 v105, v21, v89
    v_exp_f32 v26, v26
    v_mfma_f32_32x32x16_bf16 v[112:127], v[60:63], v[252:255], v[112:127]
    v_fmac_f32 v106, v21, v90
    v_exp_f32 v27, v27
    s_setprio 0
    s_waitcnt vmcnt(0)
    s_atomic_add s16, s[84:85], s91
    v_fmac_f32 v107, v21, v91
    v_exp_f32 v28, v28
    v_fmac_f32 v108, v21, v92
    v_exp_f32 v29, v29
    v_fmac_f32 v109, v21, v93
    v_exp_f32 v30, v30
    v_fmac_f32 v110, v21, v94
    v_exp_f32 v31, v31
    v_fmac_f32 v111, v21, v95
    ds_read_b128 v[80:83], v11 offset:768
    ds_read_b128 v[84:87], v11 offset:800
    ds_read_b128 v[88:91], v11 offset:832
    ds_read_b128 v[92:95], v11 offset:864
    v_fma_f32 v24, v24, v22, v22
    v_fma_f32 v25, v25, v22, v22
    v_fma_f32 v26, v26, v22, v22
    v_fma_f32 v27, v27, v22, v22
    v_fma_f32 v28, v28, v22, v22
    v_fma_f32 v29, v29, v22, v22
    v_fma_f32 v30, v30, v22, v22
    v_fma_f32 v31, v31, v22, v22
    v_rcp_f32 v24, v24
    v_mul_f32 v96, v96, v104
    v_rcp_f32 v25, v25
    v_mul_f32 v97, v97, v105
    v_rcp_f32 v26, v26
    v_mul_f32 v98, v98, v106
    v_rcp_f32 v27, v27
    v_mul_f32 v99, v99, v107
    v_rcp_f32 v28, v28
    v_mul_f32 v100, v100, v108
    v_rcp_f32 v29, v29
    v_mul_f32 v101, v101, v109
    v_rcp_f32 v30, v30
    v_mul_f32 v102, v102, v110
    v_rcp_f32 v31, v31
    v_mul_f32 v103, v103, v111
    v_mul_f32 v96, v96, v24
    v_mul_f32 v97, v97, v25
    v_mul_f32 v98, v98, v26
    v_mul_f32 v99, v99, v27
    v_mul_f32 v100, v100, v28
    v_mul_f32 v101, v101, v29
    v_mul_f32 v102, v102, v30
    v_mul_f32 v103, v103, v31
    v_cvt_pk_bf16_f32 v104, v96, v97
    v_cvt_pk_bf16_f32 v105, v98, v99
    v_cvt_pk_bf16_f32 v106, v100, v101
    v_cvt_pk_bf16_f32 v107, v102, v103
    buffer_store_dwordx4 v[104:107], v7, s[84:87], s88 offen offset:2048 sc1
    s_waitcnt lgkmcnt(0)
    v_fmac_f32 v112, v21, v80
    v_fmac_f32 v113, v21, v81
    v_fmac_f32 v114, v21, v82
    v_fmac_f32 v115, v21, v83
    v_fmac_f32 v116, v21, v84
    v_fmac_f32 v117, v21, v85
    v_fmac_f32 v118, v21, v86
    v_fmac_f32 v119, v21, v87
    v_mul_f32 v24, v23, v112
    v_mul_f32 v25, v23, v113
    v_mul_f32 v26, v23, v114
    v_mul_f32 v27, v23, v115
    v_mul_f32 v28, v23, v116
    v_mul_f32 v29, v23, v117
    v_mul_f32 v30, v23, v118
    v_mul_f32 v31, v23, v119
    v_exp_f32 v24, v24
    v_fmac_f32 v120, v21, v88
    v_exp_f32 v25, v25
    v_fmac_f32 v121, v21, v89
    v_exp_f32 v26, v26
    v_fmac_f32 v122, v21, v90
    v_exp_f32 v27, v27
    v_fmac_f32 v123, v21, v91
    v_exp_f32 v28, v28
    v_fmac_f32 v124, v21, v92
    v_exp_f32 v29, v29
    v_fmac_f32 v125, v21, v93
    v_exp_f32 v30, v30
    v_fmac_f32 v126, v21, v94
    v_exp_f32 v31, v31
    v_fmac_f32 v127, v21, v95
    v_fma_f32 v24, v24, v22, v22
    v_fma_f32 v25, v25, v22, v22
    v_fma_f32 v26, v26, v22, v22
    v_fma_f32 v27, v27, v22, v22
    v_fma_f32 v28, v28, v22, v22
    v_fma_f32 v29, v29, v22, v22
    v_fma_f32 v30, v30, v22, v22
    v_fma_f32 v31, v31, v22, v22
    v_rcp_f32 v24, v24
    v_mul_f32 v112, v112, v120
    v_rcp_f32 v25, v25
    v_mul_f32 v113, v113, v121
    v_rcp_f32 v26, v26
    v_mul_f32 v114, v114, v122
    v_rcp_f32 v27, v27
    v_mul_f32 v115, v115, v123
    v_rcp_f32 v28, v28
    v_mul_f32 v116, v116, v124
    v_rcp_f32 v29, v29
    v_mul_f32 v117, v117, v125
    v_rcp_f32 v30, v30
    v_mul_f32 v118, v118, v126
    v_rcp_f32 v31, v31
    v_mul_f32 v119, v119, v127
    v_mul_f32 v112, v112, v24
    v_mul_f32 v113, v113, v25
    v_mul_f32 v114, v114, v26
    v_mul_f32 v115, v115, v27
    v_mul_f32 v116, v116, v28
    v_mul_f32 v117, v117, v29
    v_mul_f32 v118, v118, v30
    v_mul_f32 v119, v119, v31
    v_cvt_pk_bf16_f32 v120, v112, v113
    v_cvt_pk_bf16_f32 v121, v114, v115
    v_cvt_pk_bf16_f32 v122, v116, v117
    v_cvt_pk_bf16_f32 v123, v118, v119
    buffer_store_dwordx4 v[120:123], v7, s[84:87], s88 offen offset:3072 sc1
    s_waitcnt vmcnt(0)
    s_atomic_add s16, s[84:85], s92
    s_endpgm
L_pathB:
    v_mov_b32 v20, 0
    v_mov_b32 v21, 0
    v_mov_b32 v22, 0
    v_mov_b32 v23, 0
    s_lshl_b32 s95, s2, 2
    s_add_u32 s95, s95, s3
    s_cmp_eq_u32 s2, 0
    s_cbranch_scc0 L_if_38
    s_lshl_b32 s13, s3, 11
    s_add_u32 s13, s13, 0xd80000
    buffer_store_dwordx4 v[20:23], v7, s[84:87], s13 offen offset:0 sc1
    buffer_store_dwordx4 v[20:23], v7, s[84:87], s13 offen offset:1024 sc1
L_if_38:
    s_load_dwordx2 s[72:73], s[0:1], 72
    s_load_dwordx2 s[64:65], s[0:1], 56
    s_load_dwordx2 s[68:69], s[0:1], 64
    s_load_dwordx2 s[76:77], s[0:1], 80
    s_load_dwordx2 s[88:89], s[0:1], 40
    s_lshl_b32 s13, s12, 6
    s_lshl_b32 s94, s11, 3
    s_add_u32 s13, s13, s94
    s_lshl_b32 s94, s3, 1
    s_add_u32 s94, s13, s94
    s_add_u32 m0, s90, 116736
    s_nop 0
    buffer_load_dwordx4 v3, s[44:47], s14 offen lds
    s_add_u32 m0, s90, 117776
    s_nop 0
    buffer_load_dwordx4 v3, s[44:47], s15 offen lds
    s_lshl_b32 s13, s94, 10
    buffer_load_dwordx4 v[48:51], v7, s[44:47], s13 offen offset:0
    buffer_load_dwordx4 v[52:55], v7, s[44:47], s13 offen offset:1024
    s_barrier
    s_cmp_eq_u32 s2, 0
    s_cbranch_scc0 L_if_39
    s_waitcnt vmcnt(4)
    s_mov_b32 s98, 1
    s_atomic_add s16, s[80:81], 0
    s_lshl_b32 s13, s3, 12
    s_add_u32 s13, s13, 0xd84000
    buffer_store_dwordx4 v[20:23], v7, s[84:87], s13 offen offset:0 sc1
    buffer_store_dwordx4 v[20:23], v7, s[84:87], s13 offen offset:1024 sc1
    buffer_store_dwordx4 v[20:23], v7, s[84:87], s13 offen offset:2048 sc1
    buffer_store_dwordx4 v[20:23], v7, s[84:87], s13 offen offset:3072 sc1
L_if_39:
    s_lshl_b32 s13, s94, 3
    s_add_u32 s13, s13, 0xd00000
    buffer_load_dword v95, v8, s[84:87], s13 offen
    v_add_u32 v9, 116736, v9
    s_and_b32 s96, s95, 7
    s_lshr_b32 s97, s95, 3
    s_lshl_b32 s13, s97, 14
    s_lshl_b32 s99, s96, 7
    s_add_u32 s13, s13, s99
    v_add_u32 v14, s13, v2
    s_waitcnt lgkmcnt(0)
    s_lshl_b32 s13, s10, 2
    s_load_dword s92, s[88:89], s13
    s_mul_i32 s100, s2, 1171
    s_lshr_b32 s100, s100, 16
    s_mul_i32 s99, s100, 56
    s_sub_u32 s101, s2, s99
    s_cmp_ge_u32 s101, 28
    s_cselect_b32 s40, s68, s64
    s_cselect_b32 s41, s69, s65
    s_cselect_b32 s13, 28, 0
    s_cselect_b32 s39, 256, 0
    s_mov_b32 s42, 1835008
    s_mov_b32 s43, 0x20000
    s_sub_u32 s38, s101, s13
    s_lshl_b32 s13, s38, 7
    s_lshl_b32 s37, s100, 2
    s_add_u32 s37, s37, s3
    s_mul_i32 s99, s37, 114688
    s_add_u32 s13, s13, s99
    v_lshrrev_b32 v15, 3, v1
    v_mul_u32_u24 v15, 3584, v15
    v_lshl_add_u32 v16, v5, 4, v15
    v_add_u32 v16, s13, v16
    s_waitcnt vmcnt(0)
    v_mov_b32 v18, 1
    v_mov_b32 v19, 125200
    s_mov_b64 exec, 1
    ds_add_u32 v19, v18
    s_mov_b64 exec, -1
    s_mov_b32 s98, 0
    v_mov_b32 v19, 125200
L_spin_40:
    ds_read_b32 v18, v19
    s_add_u32 s98, s98, 1
    s_waitcnt lgkmcnt(0)
    v_cmp_ne_u32 vcc, 4, v18
    s_cbranch_vccz L_sdone_41
    s_sleep 1
    s_cmp_lt_u32 s98, 0x1000000
    s_cbranch_scc1 L_spin_40
L_sdone_41:
    ds_read2_b32 v[24:25], v9 offset0:0 offset1:32
    ds_read2_b32 v[26:27], v9 offset0:64 offset1:96
    ds_read2_b32 v[28:29], v9 offset0:128 offset1:160
    ds_read2_b32 v[30:31], v9 offset0:192 offset1:224
    v_mov_b32 v84, 0x3f803f80
    v_mov_b32 v80, 0
    v_mov_b32 v81, 0
    v_mov_b32 v82, 0
    v_mov_b32 v83, 0
    v_dot2c_f32_bf16 v80, v48, v84
    v_dot2c_f32_bf16 v81, v48, v48
    v_dot2c_f32_bf16 v82, v52, v84
    v_dot2c_f32_bf16 v83, v52, v52
    v_dot2c_f32_bf16 v80, v49, v84
    v_dot2c_f32_bf16 v81, v49, v49
    v_dot2c_f32_bf16 v82, v53, v84
    v_dot2c_f32_bf16 v83, v53, v53
    v_dot2c_f32_bf16 v80, v50, v84
    v_dot2c_f32_bf16 v81, v50, v50
    v_dot2c_f32_bf16 v82, v54, v84
    v_dot2c_f32_bf16 v83, v54, v54
    v_dot2c_f32_bf16 v80, v51, v84
    v_dot2c_f32_bf16 v81, v51, v51
    v_dot2c_f32_bf16 v82, v55, v84
    v_dot2c_f32_bf16 v83, v55, v55
    s_mov_b32 s15, 0x05040100
    s_mov_b32 s99, 0x07060302
    s_mov_b32 s13, 0x200000
    s_mov_b32 s14, 0x201000
    s_waitcnt lgkmcnt(0)
    v_perm_b32 v32, v25, v24, s15
    v_perm_b32 v33, v27, v26, s15
    v_perm_b32 v34, v29, v28, s15
    v_perm_b32 v35, v31, v30, s15
    buffer_store_dwordx4 v[32:35], v6, s[84:87], s13 offen sc1
    v_perm_b32 v36, v25, v24, s99
    v_perm_b32 v37, v27, v26, s99
    v_perm_b32 v38, v29, v28, s99
    v_perm_b32 v39, v31, v30, s99
    buffer_store_dwordx4 v[36:39], v6, s[84:87], s14 offen sc1
    v_add_f32_dpp v80, v80, v80 row_shr:1 row_mask:0xf bank_mask:0xf
    v_add_f32_dpp v81, v81, v81 row_shr:1 row_mask:0xf bank_mask:0xf
    v_add_f32_dpp v82, v82, v82 row_shr:1 row_mask:0xf bank_mask:0xf
    v_add_f32_dpp v83, v83, v83 row_shr:1 row_mask:0xf bank_mask:0xf
    v_add_f32_dpp v80, v80, v80 row_shr:2 row_mask:0xf bank_mask:0xf
    v_add_f32_dpp v81, v81, v81 row_shr:2 row_mask:0xf bank_mask:0xf
    v_add_f32_dpp v82, v82, v82 row_shr:2 row_mask:0xf bank_mask:0xf
    v_add_f32_dpp v83, v83, v83 row_shr:2 row_mask:0xf bank_mask:0xf
    v_add_f32_dpp v80, v80, v80 row_shr:4 row_mask:0xf bank_mask:0xf
    v_add_f32_dpp v81, v81, v81 row_shr:4 row_mask:0xf bank_mask:0xf
    v_add_f32_dpp v82, v82, v82 row_shr:4 row_mask:0xf bank_mask:0xf
    v_add_f32_dpp v83, v83, v83 row_shr:4 row_mask:0xf bank_mask:0xf
    v_add_f32_dpp v80, v80, v80 row_shr:8 row_mask:0xf bank_mask:0xf
    v_add_f32_dpp v81, v81, v81 row_shr:8 row_mask:0xf bank_mask:0xf
    v_add_f32_dpp v82, v82, v82 row_shr:8 row_mask:0xf bank_mask:0xf
    v_add_f32_dpp v83, v83, v83 row_shr:8 row_mask:0xf bank_mask:0xf
    v_add_f32_dpp v80, v80, v80 row_bcast:15 row_mask:0xa bank_mask:0xf
    v_add_f32_dpp v81, v81, v81 row_bcast:15 row_mask:0xa bank_mask:0xf
    v_add_f32_dpp v82, v82, v82 row_bcast:15 row_mask:0xa bank_mask:0xf
    v_add_f32_dpp v83, v83, v83 row_bcast:15 row_mask:0xa bank_mask:0xf
    v_add_f32_dpp v80, v80, v80 row_bcast:31 row_mask:0xc bank_mask:0xf
    v_add_f32_dpp v81, v81, v81 row_bcast:31 row_mask:0xc bank_mask:0xf
    v_add_f32_dpp v82, v82, v82 row_bcast:31 row_mask:0xc bank_mask:0xf
    v_add_f32_dpp v83, v83, v83 row_bcast:31 row_mask:0xc bank_mask:0xf
    v_mul_f32 v80, 0x3b000000, v80
    v_mul_f32 v82, 0x3b000000, v82
    v_mul_f32 v81, 0x3b000000, v81
    v_mul_f32 v83, 0x3b000000, v83
    v_fma_f32 v81, -v80, v80, v81
    v_fma_f32 v83, -v82, v82, v83
    v_max_f32 v81, 0, v81
    v_max_f32 v83, 0, v83
    v_cvt_pk_bf16_f32 v85, v80, v81
    v_cvt_pk_bf16_f32 v86, v82, v83
    v_lshlrev_b32 v80, 16, v85
    v_lshlrev_b32 v82, 16, v86
    v_and_b32 v81, 0xffff0000, v85
    v_and_b32 v83, 0xffff0000, v86
    v_add_f32 v81, 0x3727c5ac, v81
    v_add_f32 v83, 0x3727c5ac, v83
    v_cvt_pk_bf16_f32 v85, v81, v81
    v_cvt_pk_bf16_f32 v86, v83, v83
    v_and_b32 v81, 0xffff0000, v85
    v_and_b32 v83, 0xffff0000, v86
    v_sqrt_f32 v81, v81
    v_sqrt_f32 v83, v83
    v_cvt_pk_bf16_f32 v85, v81, v81
    v_cvt_pk_bf16_f32 v86, v83, v83
    v_and_b32 v81, 0xffff0000, v85
    v_and_b32 v83, 0xffff0000, v86
    v_rcp_f32 v88, v81
    v_rcp_f32 v89, v83
    v_cmp_eq_u32 vcc, 63, v1
    v_mul_f32 v90, v80, v88
    v_mul_f32 v91, v82, v89
    s_lshl_b32 s13, s94, 3
    s_add_u32 s13, s13, 0xd00000
    v_cndmask_b32 v17, v10, v8, vcc
    buffer_store_dwordx4 v[88:91], v17, s[84:87], s13 offen sc1
    buffer_load_dword v94, v8, s[80:83], 0 offen sc1
    s_mov_b32 s98, 0
    v_mov_b32 v29, 125208
L_spin_42:
    ds_read_b32 v28, v29
    s_add_u32 s98, s98, 1
    s_waitcnt lgkmcnt(0)
    v_cmp_ne_u32 vcc, 4, v28
    s_cbranch_vccz L_sdone_43
    s_sleep 1
    s_cmp_lt_u32 s98, 0x1000000
    s_cbranch_scc1 L_spin_42
L_sdone_43:
    s_movk_i32 s99, 8192
    s_mov_b32 s13, 0
    buffer_load_dwordx4 v[136:139], v16, s[40:43], s13 offen
    s_mov_b32 s13, 28672
    buffer_load_dwordx4 v[140:143], v16, s[40:43], s13 offen
    s_mov_b32 s13, 57344
    buffer_load_dwordx4 v[144:147], v16, s[40:43], s13 offen
    s_mov_b32 s13, 86016
    buffer_load_dwordx4 v[148:151], v16, s[40:43], s13 offen
    buffer_load_dwordx4 v[128:131], v14, s[72:75], 0 offen
    buffer_load_dwordx4 v[132:135], v14, s[72:75], s99 offen
    s_waitcnt vmcnt(6)
    v_mov_b32 v28, 1
    v_mov_b32 v29, 125196
    s_mov_b64 exec, 1
    ds_add_rtn_u32 v28, v29, v28
    s_waitcnt lgkmcnt(0)
    v_cmp_eq_u32 vcc, 3, v28
    s_mov_b64 exec, -1
    s_cbranch_vccz L_bb
    s_mov_b32 s98, 0
L_flag_44:
    v_cmp_gt_u32 vcc, 4, v94
    s_cbranch_vccz L_flagok_45
    s_sleep 2
    buffer_load_dword v94, v8, s[80:83], 0 offen sc1
    s_add_u32 s98, s98, 1
    s_waitcnt vmcnt(0)
    s_cmp_lt_u32 s98, 0x100000
    s_cbranch_scc1 L_flag_44
L_flagok_45:
    s_and_b32 s14, s5, 3
    s_lshl_b32 s14, s14, 7
    s_add_u32 s14, s14, 0xd80800
    s_atomic_add s16, s[84:85], s14
    s_add_u32 s14, s14, 512
    s_atomic_add s16, s[84:85], s14
    s_add_u32 s14, s14, 512
    s_atomic_add s16, s[84:85], s14
    s_add_u32 s14, s14, 512
    s_atomic_add s16, s[84:85], s14
    s_add_u32 s14, s14, 512
    s_atomic_add s16, s[84:85], s14
    s_add_u32 s14, s14, 512
    s_atomic_add s16, s[84:85], s14
    s_add_u32 s14, s14, 512
    s_atomic_add s16, s[84:85], s14
    s_add_u32 s14, s14, 512
    s_atomic_add s16, s[84:85], s14
L_bb:
    v_mov_b32 v31, v15
    s_mul_i32 s36, s3, 25600
    v_lshrrev_b32 v17, 2, v1
    v_and_b32 v17, 4, v17
    v_xor_b32 v17, v17, v1
    v_lshl_add_u32 v17, v17, 4, s36
    v_lshrrev_b32 v24, 5, v1
    v_bfe_u32 v25, v1, 2, 2
    v_bfe_u32 v26, v1, 4, 1
    v_and_b32 v27, 3, v1
    v_bfe_u32 v19, v1, 3, 1
    v_lshlrev_b32 v14, 7, v25
    v_lshl_add_u32 v14, v26, 5, v14
    v_lshl_add_u32 v14, v27, 3, v14
    v_lshl_add_u32 v14, v19, 6, v14
    v_add_u32 v14, s36, v14
    v_lshl_add_u32 v18, v24, 9, v14
    v_xor_b32 v19, 64, v18
    v_lshl_add_u32 v14, v24, 10, v14
    v_xor_b32 v15, 64, v14
    s_lshr_b32 s13, s97, 2
    s_and_b32 s14, s97, 3
    s_mul_i32 s15, s13, 3
    s_add_u32 s15, s15, s14
    s_add_u32 s15, s15, 64
    s_lshl_b32 s13, s13, 2
    s_cmp_eq_u32 s14, 3
    s_cselect_b32 s15, s13, s15
    s_sub_u32 s13, s97, 64
    s_mul_i32 s14, s13, 21846
    s_lshr_b32 s14, s14, 16
    s_add_u32 s13, s13, s14
    s_add_u32 s13, s13, 1
    s_cmp_lt_u32 s97, 64
    s_cselect_b32 s97, s15, s13
    s_mul_i32 s13, s96, 229376
    s_lshl_b32 s14, s97, 11
    s_add_u32 s13, s13, s14
    s_add_u32 s96, s13, 0xe00000
    s_cmp_ge_u32 s2, 224
    s_cselect_b32 s95, 0x80000000, 0
    v_add_u32 v92, s95, v7
    v_and_b32 v93, 15, v1
    v_lshlrev_b32 v93, 4, v93
    v_lshl_add_u32 v93, v24, 9, v93
    v_or_b32 v93, s95, v93
    v_cmp_eq_u32 vcc, 0, v26
    s_lshl_b32 s38, s38, 2
    s_add_u32 s99, s38, 0
    s_lshr_b32 s13, s99, 2
    s_and_b32 s14, s99, 3
    s_mul_i32 s15, s13, 3
    s_add_u32 s15, s15, s14
    s_add_u32 s15, s15, 64
    s_lshl_b32 s13, s13, 2
    s_cmp_eq_u32 s14, 3
    s_cselect_b32 s15, s13, s15
    s_sub_u32 s13, s99, 64
    s_mul_i32 s14, s13, 21846
    s_lshr_b32 s14, s14, 16
    s_add_u32 s13, s13, s14
    s_add_u32 s13, s13, 1
    s_cmp_lt_u32 s99, 64
    s_cselect_b32 s99, s15, s13
    s_lshl_b32 s13, s99, 15
    s_cmp_lt_u32 s99, 64
    s_cselect_b32 s13, s13, 0x80000000
    v_mov_b32 v28, s13
    s_add_u32 s99, s38, 1
    s_lshr_b32 s13, s99, 2
    s_and_b32 s14, s99, 3
    s_mul_i32 s15, s13, 3
    s_add_u32 s15, s15, s14
    s_add_u32 s15, s15, 64
    s_lshl_b32 s13, s13, 2
    s_cmp_eq_u32 s14, 3
    s_cselect_b32 s15, s13, s15
    s_sub_u32 s13, s99, 64
    s_mul_i32 s14, s13, 21846
    s_lshr_b32 s14, s14, 16
    s_add_u32 s13, s13, s14
    s_add_u32 s13, s13, 1
    s_cmp_lt_u32 s99, 64
    s_cselect_b32 s99, s15, s13
    s_lshl_b32 s13, s99, 15
    s_cmp_lt_u32 s99, 64
    s_cselect_b32 s13, s13, 0x80000000
    v_mov_b32 v29, s13
    v_cndmask_b32 v28, v29, v28, vcc
    v_or_b32 v117, v28, v93
    s_add_u32 s99, s38, 2
    s_lshr_b32 s13, s99, 2
    s_and_b32 s14, s99, 3
    s_mul_i32 s15, s13, 3
    s_add_u32 s15, s15, s14
    s_add_u32 s15, s15, 64
    s_lshl_b32 s13, s13, 2
    s_cmp_eq_u32 s14, 3
    s_cselect_b32 s15, s13, s15
    s_sub_u32 s13, s99, 64
    s_mul_i32 s14, s13, 21846
    s_lshr_b32 s14, s14, 16
    s_add_u32 s13, s13, s14
    s_add_u32 s13, s13, 1
    s_cmp_lt_u32 s99, 64
    s_cselect_b32 s99, s15, s13
    s_lshl_b32 s13, s99, 15
    s_cmp_lt_u32 s99, 64
    s_cselect_b32 s13, s13, 0x80000000
    v_mov_b32 v28, s13
    s_add_u32 s99, s38, 3
    s_lshr_b32 s13, s99, 2
    s_and_b32 s14, s99, 3
    s_mul_i32 s15, s13, 3
    s_add_u32 s15, s15, s14
    s_add_u32 s15, s15, 64
    s_lshl_b32 s13, s13, 2
    s_cmp_eq_u32 s14, 3
    s_cselect_b32 s15, s13, s15
    s_sub_u32 s13, s99, 64
    s_mul_i32 s14, s13, 21846
    s_lshr_b32 s14, s14, 16
    s_add_u32 s13, s13, s14
    s_add_u32 s13, s13, 1
    s_cmp_lt_u32 s99, 64
    s_cselect_b32 s99, s15, s13
    s_lshl_b32 s13, s99, 15
    s_cmp_lt_u32 s99, 64
    s_cselect_b32 s13, s13, 0x80000000
    v_mov_b32 v29, s13
    v_cndmask_b32 v28, v29, v28, vcc
    v_or_b32 v118, v28, v93
    s_lshl_b32 s38, s37, 11
    s_add_u32 s38, s38, s39
    s_add_u32 s38, s38, 0x1010000
    v_mov_b32 v26, 0x3f80
    v_and_b32 v27, 1, v1
    v_lshlrev_b32 v27, 4, v27
    v_lshlrev_b32 v26, v27, v26
    v_bfe_u32 v27, v1, 1, 3
    v_cmp_eq_u32 vcc, 0, v27
    s_nop 1
    v_cndmask_b32 v44, v8, v26, vcc
    v_cmp_eq_u32 vcc, 1, v27
    s_nop 1
    v_cndmask_b32 v45, v8, v26, vcc
    v_cmp_eq_u32 vcc, 2, v27
    s_nop 1
    v_cndmask_b32 v46, v8, v26, vcc
    v_cmp_eq_u32 vcc, 3, v27
    s_nop 1
    v_cndmask_b32 v47, v8, v26, vcc
    s_waitcnt vmcnt(0)
    ds_write_b128 v17, v[128:131] offset:0
    ds_write_b128 v17, v[132:135] offset:1024
    ds_write_b128 v17, v[136:139] offset:2048
    ds_write_b128 v17, v[140:143] offset:3072
    ds_write_b128 v17, v[144:147] offset:4096
    ds_write_b128 v17, v[148:151] offset:5120
    v_mfma_f32_16x16x32_bf16 v[40:43], v[44:47], v[136:139], 0
    v_mfma_f32_16x16x32_bf16 v[40:43], v[44:47], v[140:143], v[40:43]
    v_mfma_f32_16x16x32_bf16 v[40:43], v[44:47], v[144:147], v[40:43]
    v_mfma_f32_16x16x32_bf16 v[40:43], v[44:47], v[148:151], v[40:43]
    s_waitcnt lgkmcnt(0)
    ds_read_b64_tr_b16 v[152:153], v14 offset:2048
    ds_read_b64_tr_b16 v[154:155], v14 offset:2560
    ds_read_b64_tr_b16 v[156:157], v15 offset:2048
    ds_read_b64_tr_b16 v[158:159], v15 offset:2560
    ds_read_b64_tr_b16 v[160:161], v14 offset:4096
    ds_read_b64_tr_b16 v[162:163], v14 offset:4608
    ds_read_b64_tr_b16 v[164:165], v15 offset:4096
    ds_read_b64_tr_b16 v[166:167], v15 offset:4608
    ds_read_b64_tr_b16 v[128:129], v18 offset:0
    ds_read_b64_tr_b16 v[130:131], v18 offset:1024
    ds_read_b64_tr_b16 v[132:133], v19 offset:0
    ds_read_b64_tr_b16 v[134:135], v19 offset:1024
    s_waitcnt lgkmcnt(0)
    v_add_u32 v28, 0, v1
    v_mul_u32_u24 v29, 10923, v28
    v_lshrrev_b32 v29, 16, v29
    v_mul_u32_u24 v30, 6, v29
    v_sub_u32 v30, v28, v30
    v_mul_u32_u24 v29, 3584, v29
    v_lshl_add_u32 v11, v30, 4, v29
    v_add_u32 v28, 64, v1
    v_mul_u32_u24 v29, 10923, v28
    v_lshrrev_b32 v29, 16, v29
    v_mul_u32_u24 v30, 6, v29
    v_sub_u32 v30, v28, v30
    v_mul_u32_u24 v29, 3584, v29
    v_lshl_add_u32 v12, v30, 4, v29
    v_add_u32 v28, 128, v1
    v_mul_u32_u24 v29, 10923, v28
    v_lshrrev_b32 v29, 16, v29
    v_mul_u32_u24 v30, 6, v29
    v_sub_u32 v30, v28, v30
    v_mul_u32_u24 v29, 3584, v29
    v_lshl_add_u32 v13, v30, 4, v29
    s_lshl_b32 s90, s9, 1
    s_lshl_b32 s91, s7, 7
    s_lshl_b32 s36, s3, 2
    s_and_b32 s37, s6, 3
    v_mov_b32 v116, v92
    v_add_f32_dpp v44, v40, v40 row_ror:8 row_mask:0xf bank_mask:0xf
    v_add_f32_dpp v45, v41, v41 row_ror:8 row_mask:0xf bank_mask:0xf
    v_add_f32_dpp v46, v42, v42 row_ror:8 row_mask:0xf bank_mask:0xf
    v_add_f32_dpp v47, v43, v43 row_ror:8 row_mask:0xf bank_mask:0xf
    v_lshrrev_b32 v27, 4, v1
    v_lshlrev_b32 v24, 5, v5
    v_lshl_add_u32 v24, v27, 4, v24
    s_lshl_b32 s13, s3, 8
    s_add_u32 s13, s13, 125440
    v_add_u32 v24, s13, v24
    v_and_b32 v25, 40, v1
    v_cmp_eq_u32 vcc, 0, v25
    v_mov_b32 v25, 125216
    s_nop 0
    v_cndmask_b32 v24, v25, v24, vcc
    ds_write_b128 v24, v[44:47]
    s_waitcnt lgkmcnt(0)
    v_mov_b32 v28, 1
    v_mov_b32 v29, 125204
    s_mov_b64 exec, 1
    ds_add_u32 v29, v28
    s_mov_b64 exec, -1
    s_mov_b32 s88, s96
    s_mov_b32 s89, s95
    s_mul_i32 s13, s100, 14336
    s_lshl_b32 s14, s101, 8
    s_add_u32 s13, s13, s14
    s_add_u32 s101, s13, 0xd10000
    v_mov_b32 v16, 0
    v_mov_b32 v17, 0
    v_mov_b32 v18, 0
    v_mov_b32 v19, 0
    s_mov_b32 s100, s36
    s_mov_b32 s95, s37
    v_and_b32 v20, 15, v1
    v_lshlrev_b32 v21, 4, v20
    v_lshl_add_u32 v21, v27, 2, v21
    v_lshlrev_b32 v22, 1, v21
    v_xor_b32 v23, 8, v22
    v_lshlrev_b32 v21, 3, v21
    v_lshrrev_b32 v24, 1, v20
    v_lshlrev_b32 v24, 15, v24
    v_and_b32 v25, 1, v20
    v_lshl_add_u32 v25, v25, 2, v27
    v_lshl_add_u32 v24, v25, 4, v24
    s_lshl_b32 s13, s3, 11
    s_add_u32 s13, s13, 131072
    v_add_u32 v25, s13, v7
    s_mul_i32 s94, s9, 229376
    s_add_u32 s94, s94, 0xe00000
    s_lshl_b32 s13, s3, 15
    s_add_u32 s96, s94, s13
    s_mul_i32 s13, s3, 24576
    s_add_u32 s97, s94, s13
    s_add_u32 s97, s97, 131072
    s_lshl_b32 s13, s37, 1
    s_add_u32 s13, s13, s9
    s_lshr_b32 s36, s9, 1
    s_add_u32 s36, s36, s37
    s_cmp_ge_u32 s13, 6
    s_cselect_b32 s14, 6, 0
    s_sub_u32 s13, s13, s14
    s_cmp_ge_u32 s13, 6
    s_cselect_b32 s14, 6, 0
    s_sub_u32 s37, s13, s14
    v_lshlrev_b32 v15, 7, v1
    s_lshl_b32 s13, s2, 10
    s_add_u32 s13, s13, 0xd20000
    s_lshl_b32 s14, s2, 9
    s_add_u32 s14, s14, 0xd9fc00
    s_cmp_eq_u32 s3, 0
    s_cselect_b32 s13, s13, s14
    v_lshlrev_b32 v30, 4, v0
    v_cmp_gt_u32 vcc, 96, v0
    s_nop 1
    v_cndmask_b32 v30, v10, v30, vcc
    buffer_store_dwordx4 v[16:19], v30, s[84:87], s13 offen sc1
    v_lshlrev_b32 v26, 2, v1
    s_cmp_eq_u32 s3, 0
    s_cbranch_scc0 L_if_46
    s_mov_b32 s98, 0
    v_mov_b32 v29, 125204
L_spin_47:
    ds_read_b32 v28, v29
    s_add_u32 s98, s98, 1
    s_waitcnt lgkmcnt(0)
    v_cmp_ne_u32 vcc, 4, v28
    s_cbranch_vccz L_sdone_48
    s_sleep 1
    s_cmp_lt_u32 s98, 0x1000000
    s_cbranch_scc1 L_spin_47
L_sdone_48:
    v_add_u32 v28, 125440, v26
    ds_read_b32 v112, v28 offset:0
    ds_read_b32 v113, v28 offset:256
    ds_read_b32 v114, v28 offset:512
    ds_read_b32 v115, v28 offset:768
    v_add_u32 v29, s89, v26
    s_waitcnt lgkmcnt(0)
    v_add_f32 v112, v112, v113
    v_add_f32 v114, v114, v115
    v_add_f32 v112, v112, v114
    buffer_store_dword v112, v29, s[84:87], s101 offen sc1
L_if_46:
    s_mov_b32 s98, 0
    v_mov_b32 v29, 125184
L_spin_49:
    ds_read_b32 v28, v29
    s_add_u32 s98, s98, 1
    s_waitcnt lgkmcnt(0)
    v_cmp_ne_u32 vcc, 5, v28
    s_cbranch_vccz L_sdone_50
    s_sleep 1
    s_cmp_lt_u32 s98, 0x1000000
    s_cbranch_scc1 L_spin_49
L_sdone_50:
    s_setprio 1
    s_cmp_eq_u32 s3, 1
    s_cbranch_scc0 L_if_51
    s_and_b32 s13, s2, 7
    s_mul_i32 s13, s13, 512
    s_add_u32 s13, s13, 0xd80800
    s_mov_b32 s98, 0
L_fp_52:
    s_mov_b32 s14, s13
    s_mov_b32 s48, 0
    s_atomic_add s48, s[84:85], s14 glc
    s_add_u32 s14, s14, 128
    s_mov_b32 s49, 0
    s_atomic_add s49, s[84:85], s14 glc
    s_add_u32 s14, s14, 128
    s_mov_b32 s50, 0
    s_atomic_add s50, s[84:85], s14 glc
    s_add_u32 s14, s14, 128
    s_mov_b32 s51, 0
    s_atomic_add s51, s[84:85], s14 glc
    s_add_u32 s98, s98, 1
    s_waitcnt lgkmcnt(0)
    s_add_u32 s48, s48, s49
    s_add_u32 s48, s48, s50
    s_add_u32 s48, s48, s51
    s_cmp_ge_u32 s48, 256
    s_cbranch_scc1 L_fd_53
    s_sleep 1
    s_cmp_lt_u32 s98, 0x100000
    s_cbranch_scc1 L_fp_52
L_fd_53:
    v_mov_b32 v28, 1
    v_mov_b32 v29, 125188
    s_mov_b64 exec, 1
    ds_add_u32 v29, v28
    s_mov_b64 exec, -1
L_if_51:
    s_mov_b32 s98, 0
    v_mov_b32 v29, 125188
L_spin_54:
    ds_read_b32 v28, v29
    s_add_u32 s98, s98, 1
    s_waitcnt lgkmcnt(0)
    v_cmp_ne_u32 vcc, 5, v28
    s_cbranch_vccz L_sdone_55
    s_sleep 1
    s_cmp_lt_u32 s98, 0x1000000
    s_cbranch_scc1 L_spin_54
L_sdone_55:
    s_lshl_b32 s13, s10, 13
    s_lshl_b32 s14, s3, 10
    s_add_u32 s13, s13, s14
    s_add_u32 s14, s13, 4096
    s_add_u32 s15, s13, 0x200000
    s_add_u32 s99, s14, 0x200000
    buffer_load_dwordx2 v[32:33], v22, s[84:87], s15 offen offset:0 sc1
    buffer_load_dwordx2 v[40:41], v23, s[84:87], s13 offen offset:0 sc1
    buffer_load_dwordx2 v[34:35], v22, s[84:87], s15 offen offset:512 sc1
    buffer_load_dwordx2 v[42:43], v23, s[84:87], s13 offen offset:512 sc1
    buffer_load_dwordx2 v[36:37], v22, s[84:87], s99 offen offset:0 sc1
    buffer_load_dwordx2 v[44:45], v23, s[84:87], s14 offen offset:0 sc1
    buffer_load_dwordx2 v[38:39], v22, s[84:87], s99 offen offset:512 sc1
    buffer_load_dwordx2 v[46:47], v23, s[84:87], s14 offen offset:512 sc1
    s_lshl_b32 s13, s3, 12
    s_add_u32 s13, s13, 0xd00000
    buffer_load_dwordx4 v[96:99], v21, s[84:87], s13 offen offset:0 sc1
    buffer_load_dwordx4 v[100:103], v21, s[84:87], s13 offen offset:16 sc1
    buffer_load_dwordx4 v[104:107], v21, s[84:87], s13 offen offset:2048 sc1
    buffer_load_dwordx4 v[108:111], v21, s[84:87], s13 offen offset:2064 sc1
    buffer_store_dwordx4 v[152:155], v117, s[84:87], s38 offen offset:0 sc1
    buffer_store_dwordx4 v[156:159], v118, s[84:87], s38 offen offset:0 sc1
    buffer_store_dwordx4 v[160:163], v117, s[84:87], s38 offen offset:1024 sc1
    buffer_store_dwordx4 v[164:167], v118, s[84:87], s38 offen offset:1024 sc1
    buffer_store_dwordx4 v[128:131], v116, s[84:87], s88 offen offset:0 sc1
    buffer_store_dwordx4 v[132:135], v116, s[84:87], s88 offen offset:1024 sc1
    s_waitcnt lgkmcnt(0)
    s_lshl_b32 s12, s92, 16
    s_and_b32 s11, s92, s93
    s_waitcnt vmcnt(6)
    v_lshlrev_b32 v64, 16, v32
    v_and_b32 v65, s93, v32
    v_lshlrev_b32 v66, 16, v33
    v_and_b32 v67, s93, v33
    v_and_b32 v80, s93, v41
    v_lshlrev_b32 v81, 16, v41
    v_and_b32 v82, s93, v40
    v_lshlrev_b32 v83, 16, v40
    v_lshlrev_b32 v68, 16, v34
    v_and_b32 v69, s93, v34
    v_lshlrev_b32 v70, 16, v35
    v_and_b32 v71, s93, v35
    v_and_b32 v84, s93, v43
    v_lshlrev_b32 v85, 16, v43
    v_and_b32 v86, s93, v42
    v_lshlrev_b32 v87, 16, v42
    v_lshlrev_b32 v72, 16, v36
    v_and_b32 v73, s93, v36
    v_lshlrev_b32 v74, 16, v37
    v_and_b32 v75, s93, v37
    v_and_b32 v88, s93, v45
    v_lshlrev_b32 v89, 16, v45
    v_and_b32 v90, s93, v44
    v_lshlrev_b32 v91, 16, v44
    v_lshlrev_b32 v76, 16, v38
    v_and_b32 v77, s93, v38
    v_lshlrev_b32 v78, 16, v39
    v_and_b32 v79, s93, v39
    v_and_b32 v92, s93, v47
    v_lshlrev_b32 v93, 16, v47
    v_and_b32 v94, s93, v46
    v_lshlrev_b32 v95, 16, v46
    v_mul_f32 v80, s12, v80
    v_mul_f32 v81, s12, v81
    v_mul_f32 v82, s12, v82
    v_mul_f32 v83, s12, v83
    v_mul_f32 v84, s12, v84
    v_mul_f32 v85, s12, v85
    v_mul_f32 v86, s12, v86
    v_mul_f32 v87, s12, v87
    v_mul_f32 v88, s11, v88
    v_mul_f32 v89, s11, v89
    v_mul_f32 v90, s11, v90
    v_mul_f32 v91, s11, v91
    v_mul_f32 v92, s11, v92
    v_mul_f32 v93, s11, v93
    v_mul_f32 v94, s11, v94
    v_mul_f32 v95, s11, v95
    s_add_u32 s99, s95, 0
    s_and_b32 s99, s99, 3
    s_add_u32 s99, s99, s100
    s_cmp_eq_u32 s99, 15
    s_cbranch_scc1 L_ue_56
    s_add_u32 s14, s99, s90
    s_and_b32 s14, s14, 15
    s_mul_i32 s14, s14, 114688
    s_add_u32 s14, s14, s91
    s_mul_i32 s13, s99, 6400
    s_add_u32 m0, s13, 0
    s_nop 0
    buffer_load_dwordx4 v11, s[64:67], s14 offen lds
    s_add_u32 m0, s13, 1024
    s_nop 0
    buffer_load_dwordx4 v12, s[64:67], s14 offen lds
    s_add_u32 m0, s13, 2048
    s_nop 0
    buffer_load_dwordx4 v13, s[64:67], s14 offen lds
    s_add_u32 m0, s13, 3200
    s_nop 0
    buffer_load_dwordx4 v11, s[68:71], s14 offen lds
    s_add_u32 m0, s13, 4224
    s_nop 0
    buffer_load_dwordx4 v12, s[68:71], s14 offen lds
    s_add_u32 m0, s13, 5248
    s_nop 0
    buffer_load_dwordx4 v13, s[68:71], s14 offen lds
L_ue_56:
    s_lshl_b32 s13, s3, 19
    s_lshl_b32 s14, s10, 7
    s_add_u32 s13, s13, s14
    s_add_u32 s38, s13, 0x400000
    s_add_u32 s39, s38, 0x40000
    v_lshlrev_b32 v27, 2, v1
    v_and_b32 v30, 3, v1
    v_lshlrev_b32 v30, 13, v30
    v_add_u32 v30, 137216, v30
    s_setprio 0
    s_barrier
    ds_read_b128 v[32:35], v25 offset:0
    ds_read_b128 v[40:43], v25 offset:8192
    ds_read_b128 v[48:51], v25 offset:16384
    ds_read_b128 v[56:59], v25 offset:24576
    ds_read_b128 v[36:39], v25 offset:1024
    ds_read_b128 v[44:47], v25 offset:9216
    ds_read_b128 v[52:55], v25 offset:17408
    ds_read_b128 v[60:63], v25 offset:25600
    v_pk_fma_f32 v[120:121], v[64:65], v[96:97], v[98:99] neg_lo:[0,0,1] neg_hi:[0,0,1]
    v_pk_fma_f32 v[122:123], v[66:67], v[100:101], v[102:103] neg_lo:[0,0,1] neg_hi:[0,0,1]
    v_pk_fma_f32 v[128:129], v[72:73], v[96:97], v[98:99] neg_lo:[0,0,1] neg_hi:[0,0,1]
    v_pk_fma_f32 v[130:131], v[74:75], v[100:101], v[102:103] neg_lo:[0,0,1] neg_hi:[0,0,1]
    v_pk_fma_f32 v[124:125], v[68:69], v[104:105], v[106:107] neg_lo:[0,0,1] neg_hi:[0,0,1]
    v_pk_fma_f32 v[126:127], v[70:71], v[108:109], v[110:111] neg_lo:[0,0,1] neg_hi:[0,0,1]
    v_pk_fma_f32 v[132:133], v[76:77], v[104:105], v[106:107] neg_lo:[0,0,1] neg_hi:[0,0,1]
    v_pk_fma_f32 v[134:135], v[78:79], v[108:109], v[110:111] neg_lo:[0,0,1] neg_hi:[0,0,1]
    s_waitcnt lgkmcnt(4)
    v_pk_add_f32 v[32:33], v[32:33], v[80:81]
    v_pk_add_f32 v[34:35], v[34:35], v[82:83]
    v_pk_add_f32 v[48:49], v[48:49], v[88:89]
    v_pk_add_f32 v[50:51], v[50:51], v[90:91]
    v_pk_add_f32 v[32:33], v[32:33], v[40:41]
    v_pk_add_f32 v[34:35], v[34:35], v[42:43]
    v_pk_add_f32 v[48:49], v[48:49], v[56:57]
    v_pk_add_f32 v[50:51], v[50:51], v[58:59]
    v_pk_fma_f32 v[64:65], v[120:121], v[32:33], v[64:65]
    v_pk_fma_f32 v[66:67], v[122:123], v[34:35], v[66:67]
    v_pk_fma_f32 v[72:73], v[128:129], v[48:49], v[72:73]
    v_pk_fma_f32 v[74:75], v[130:131], v[50:51], v[74:75]
    v_cvt_pk_bf16_f32 v112, v64, v65
    v_cvt_pk_bf16_f32 v113, v66, v67
    v_cvt_pk_bf16_f32 v114, v72, v73
    v_cvt_pk_bf16_f32 v115, v74, v75
    buffer_store_dwordx4 v[112:115], v24, s[84:87], s38 offen sc1
    s_waitcnt lgkmcnt(0)
    v_pk_add_f32 v[36:37], v[36:37], v[84:85]
    v_pk_add_f32 v[38:39], v[38:39], v[86:87]
    v_pk_add_f32 v[52:53], v[52:53], v[92:93]
    v_pk_add_f32 v[54:55], v[54:55], v[94:95]
    v_pk_add_f32 v[36:37], v[36:37], v[44:45]
    v_pk_add_f32 v[38:39], v[38:39], v[46:47]
    v_pk_add_f32 v[52:53], v[52:53], v[60:61]
    v_pk_add_f32 v[54:55], v[54:55], v[62:63]
    v_pk_fma_f32 v[68:69], v[124:125], v[36:37], v[68:69]
    v_pk_fma_f32 v[70:71], v[126:127], v[38:39], v[70:71]
    v_pk_fma_f32 v[76:77], v[132:133], v[52:53], v[76:77]
    v_pk_fma_f32 v[78:79], v[134:135], v[54:55], v[78:79]
    v_cvt_pk_bf16_f32 v116, v68, v69
    v_cvt_pk_bf16_f32 v117, v70, v71
    v_cvt_pk_bf16_f32 v118, v76, v77
    v_cvt_pk_bf16_f32 v119, v78, v79
    buffer_store_dwordx4 v[116:119], v24, s[84:87], s39 offen sc1
    s_cmp_eq_u32 s3, 3
    s_cbranch_scc0 L_if_57
    ds_write_b32 v30, v8
L_if_57:
    s_waitcnt vmcnt(0) lgkmcnt(0)
    s_barrier
    s_add_u32 s99, s95, 1
    s_and_b32 s99, s99, 3
    s_add_u32 s99, s99, s100
    s_cmp_eq_u32 s99, 15
    s_cbranch_scc1 L_ue_58
    s_add_u32 s14, s99, s90
    s_and_b32 s14, s14, 15
    s_mul_i32 s14, s14, 114688
    s_add_u32 s14, s14, s91
    s_mul_i32 s13, s99, 6400
    s_add_u32 m0, s13, 0
    s_waitcnt vmcnt(10)
    buffer_load_dwordx4 v11, s[64:67], s14 offen lds
    s_add_u32 m0, s13, 1024
    s_waitcnt vmcnt(10)
    buffer_load_dwordx4 v12, s[64:67], s14 offen lds
    s_add_u32 m0, s13, 2048
    s_waitcnt vmcnt(10)
    buffer_load_dwordx4 v13, s[64:67], s14 offen lds
    s_add_u32 m0, s13, 3200
    s_waitcnt vmcnt(10)
    buffer_load_dwordx4 v11, s[68:71], s14 offen lds
    s_add_u32 m0, s13, 4224
    s_waitcnt vmcnt(10)
    buffer_load_dwordx4 v12, s[68:71], s14 offen lds
    s_add_u32 m0, s13, 5248
    s_waitcnt vmcnt(10)
    buffer_load_dwordx4 v13, s[68:71], s14 offen lds
L_ue_58:
    s_add_u32 s99, s95, 2
    s_and_b32 s99, s99, 3
    s_add_u32 s99, s99, s100
    s_cmp_eq_u32 s99, 15
    s_cbranch_scc1 L_ue_59
    s_add_u32 s14, s99, s90
    s_and_b32 s14, s14, 15
    s_mul_i32 s14, s14, 114688
    s_add_u32 s14, s14, s91
    s_mul_i32 s13, s99, 6400
    s_add_u32 m0, s13, 0
    s_waitcnt vmcnt(10)
    buffer_load_dwordx4 v11, s[64:67], s14 offen lds
    s_add_u32 m0, s13, 1024
    s_waitcnt vmcnt(10)
    buffer_load_dwordx4 v12, s[64:67], s14 offen lds
    s_add_u32 m0, s13, 2048
    s_waitcnt vmcnt(10)
    buffer_load_dwordx4 v13, s[64:67], s14 offen lds
    s_add_u32 m0, s13, 3200
    s_waitcnt vmcnt(10)
    buffer_load_dwordx4 v11, s[68:71], s14 offen lds
    s_add_u32 m0, s13, 4224
    s_waitcnt vmcnt(10)
    buffer_load_dwordx4 v12, s[68:71], s14 offen lds
    s_add_u32 m0, s13, 5248
    s_waitcnt vmcnt(10)
    buffer_load_dwordx4 v13, s[68:71], s14 offen lds
L_ue_59:
    s_add_u32 s99, s95, 3
    s_and_b32 s99, s99, 3
    s_add_u32 s99, s99, s100
    s_cmp_eq_u32 s99, 15
    s_cbranch_scc1 L_ue_60
    s_add_u32 s14, s99, s90
    s_and_b32 s14, s14, 15
    s_mul_i32 s14, s14, 114688
    s_add_u32 s14, s14, s91
    s_mul_i32 s13, s99, 6400
    s_add_u32 m0, s13, 0
    s_waitcnt vmcnt(10)
    buffer_load_dwordx4 v11, s[64:67], s14 offen lds
    s_add_u32 m0, s13, 1024
    s_waitcnt vmcnt(10)
    buffer_load_dwordx4 v12, s[64:67], s14 offen lds
    s_add_u32 m0, s13, 2048
    s_waitcnt vmcnt(10)
    buffer_load_dwordx4 v13, s[64:67], s14 offen lds
    s_add_u32 m0, s13, 3200
    s_waitcnt vmcnt(10)
    buffer_load_dwordx4 v11, s[68:71], s14 offen lds
    s_add_u32 m0, s13, 4224
    s_waitcnt vmcnt(10)
    buffer_load_dwordx4 v12, s[68:71], s14 offen lds
    s_add_u32 m0, s13, 5248
    s_waitcnt vmcnt(10)
    buffer_load_dwordx4 v13, s[68:71], s14 offen lds
L_ue_60:
    s_cmp_lg_u32 s3, 3
    s_cbranch_scc1 L_nou15
    s_mov_b32 s99, 15
    s_add_u32 s14, s99, s90
    s_and_b32 s14, s14, 15
    s_mul_i32 s14, s14, 114688
    s_add_u32 s14, s14, s91
    s_mul_i32 s13, s99, 6400
    s_add_u32 m0, s13, 0
    s_waitcnt vmcnt(10)
    buffer_load_dwordx4 v11, s[64:67], s14 offen lds
    s_add_u32 m0, s13, 1024
    s_waitcnt vmcnt(10)
    buffer_load_dwordx4 v12, s[64:67], s14 offen lds
    s_add_u32 m0, s13, 2048
    s_waitcnt vmcnt(10)
    buffer_load_dwordx4 v13, s[64:67], s14 offen lds
    s_add_u32 m0, s13, 3200
    s_waitcnt vmcnt(10)
    buffer_load_dwordx4 v11, s[68:71], s14 offen lds
    s_add_u32 m0, s13, 4224
    s_waitcnt vmcnt(10)
    buffer_load_dwordx4 v12, s[68:71], s14 offen lds
    s_add_u32 m0, s13, 5248
    s_waitcnt vmcnt(10)
    buffer_load_dwordx4 v13, s[68:71], s14 offen lds
L_nou15:
    s_lshl_b32 s100, s7, 17
    s_add_u32 s100, s100, 0x1010000
    s_lshl_b32 s13, s3, 1
    s_add_u32 s13, s13, s9
    s_add_u32 s13, s13, 0
    s_and_b32 s13, s13, 7
    s_lshl_b32 s13, s13, 12
    s_add_u32 s40, s13, s100
    s_lshl_b32 s13, s3, 1
    s_add_u32 s13, s13, s9
    s_add_u32 s13, s13, 1
    s_and_b32 s13, s13, 7
    s_lshl_b32 s13, s13, 12
    s_add_u32 s41, s13, s100
    s_lshl_b32 s42, s3, 13
    s_lshl_b32 s43, s3, 12
    s_lshl_b32 s13, s95, 13
    s_add_u32 s100, s100, s13
    s_lshl_b32 s13, s3, 15
    s_add_u32 s100, s100, s13
    s_mul_i32 s92, s95, 57344
    s_add_u32 s92, s92, s94
    s_lshl_b32 s14, s3, 14
    s_add_u32 s92, s92, s14
    s_lshl_b32 s95, s6, 2
    s_add_u32 s95, s95, s3
    v_lshrrev_b32 v16, 5, v0
    v_lshlrev_b32 v16, 4, v16
    v_and_b32 v17, 15, v0
    v_add_u32 v16, v16, v17
    s_lshl_b32 s13, s7, 6
    s_mul_i32 s14, s7, 48
    s_add_u32 s14, s14, 960
    v_mov_b32 v17, s13
    v_mov_b32 v18, s14
    v_cmp_gt_u32 vcc, 128, v0
    s_nop 1
    v_cndmask_b32 v17, v18, v17, vcc
    v_add_u32 v16, v16, v17
    v_bfe_u32 v17, v1, 4, 1
    v_mul_u32_u24 v17, 1792, v17
    v_add_u32 v16, v16, v17
    v_lshlrev_b32 v16, 2, v16
    s_lshl_b32 s13, s95, 15
    s_lshl_b32 s14, s9, 12
    s_add_u32 s13, s13, s14
    s_lshl_b32 s14, s8, 11
    s_add_u32 s13, s13, s14
    s_add_u32 s94, s13, 0x400000
    s_lshl_b32 s101, s95, 12
    s_add_u32 s101, s101, 0xd20000
    v_bfe_u32 v17, v1, 3, 1
    v_bfe_u32 v18, v1, 4, 1
    v_lshl_add_u32 v18, v17, 1, v18
    v_lshl_add_u32 v18, v5, 2, v18
    v_and_b32 v19, 32, v1
    v_add_u32 v18, v18, v19
    v_lshlrev_b32 v18, 2, v18
    s_waitcnt vmcnt(0) lgkmcnt(0)
    v_add_u32 v104, 103296, v27
    s_mov_b32 exec_hi, 0
    ds_write_b32 v104, v8
    s_mov_b32 exec_hi, -1
    v_mov_b32 v104, 103296
    s_lshl_b32 s13, s3, 2
    s_add_u32 s13, s13, 103296
    v_mov_b32 v105, s13
    v_mov_b32 v106, 1
    s_waitcnt lgkmcnt(0)
    s_barrier
    s_setprio 0
    buffer_load_dwordx4 v[32:35], v7, s[84:87], s94 offen offset:0 sc1
    buffer_load_dwordx4 v[36:39], v7, s[84:87], s94 offen offset:1024 sc1
    s_mov_b32 s13, 0xd10000
    buffer_load_dword v20, v16, s[84:87], s13 offen sc1
    s_mov_b32 s13, 0xd13800
    buffer_load_dword v21, v16, s[84:87], s13 offen sc1
    s_mov_b32 s13, 0xd17000
    buffer_load_dword v22, v16, s[84:87], s13 offen sc1
    s_mov_b32 s13, 0xd1a800
    buffer_load_dword v23, v16, s[84:87], s13 offen sc1
    s_mul_i32 s94, s95, 114688
    s_add_u32 s94, s94, 0x600000
    s_lshl_b32 s13, s7, 12
    s_add_u32 s88, s94, s13
    s_mul_i32 s13, s7, 3072
    s_add_u32 s89, s94, s13
    s_add_u32 s89, s89, 65536
    s_lshr_b32 s13, s3, 1
    s_lshl_b32 s14, s6, 1
    s_add_u32 s13, s13, s14
    s_lshl_b32 s13, s13, 2
    s_lshr_b32 s14, s7, 2
    s_add_u32 s13, s13, s14
    s_lshl_b32 s13, s13, 10
    s_add_u32 s38, s13, 0xda0000
    s_lshl_b32 s13, s6, 1
    s_add_u32 s13, s13, s8
    s_mul_i32 s94, s13, 229376
    s_add_u32 s94, s94, 0x600000
    s_lshl_b32 s13, s13, 2
    s_add_u32 s13, s13, s3
    s_lshl_b32 s13, s13, 10
    s_add_u32 s39, s13, 0xda0000
    s_lshl_b32 s13, s3, 14
    s_add_u32 s90, s94, s13
    s_mul_i32 s13, s3, 12288
    s_add_u32 s91, s94, s13
    s_add_u32 s91, s91, 65536
    v_lshrrev_b32 v3, 5, v1
    v_lshlrev_b32 v3, 4, v3
    v_add_u32 v3, 102400, v3
    s_add_u32 s13, s42, 131072
    v_add_u32 v4, s13, v7
    v_add_u32 v13, s43, v7
    v_add_u32 v14, 0x10000, v13
    s_waitcnt vmcnt(4)
    v_lshlrev_b32 v48, 16, v32
    v_and_b32 v49, s93, v32
    v_lshlrev_b32 v50, 16, v33
    v_and_b32 v51, s93, v33
    v_lshlrev_b32 v52, 16, v34
    v_and_b32 v53, s93, v34
    v_lshlrev_b32 v54, 16, v35
    v_and_b32 v55, s93, v35
    v_lshlrev_b32 v56, 16, v36
    v_and_b32 v57, s93, v36
    v_lshlrev_b32 v58, 16, v37
    v_and_b32 v59, s93, v37
    v_lshlrev_b32 v60, 16, v38
    v_and_b32 v61, s93, v38
    v_lshlrev_b32 v62, 16, v39
    v_and_b32 v63, s93, v39
    v_mul_f32 v44, v48, v48
    v_mul_f32 v45, v49, v49
    v_mul_f32 v46, v50, v50
    v_mul_f32 v47, v51, v51
    v_fmac_f32 v44, v52, v52
    v_add_f32 v48, v48, v52
    v_fmac_f32 v45, v53, v53
    v_add_f32 v49, v49, v53
    v_fmac_f32 v46, v54, v54
    v_add_f32 v50, v50, v54
    v_fmac_f32 v47, v55, v55
    v_add_f32 v51, v51, v55
    v_fmac_f32 v44, v56, v56
    v_add_f32 v48, v48, v56
    v_fmac_f32 v45, v57, v57
    v_add_f32 v49, v49, v57
    v_fmac_f32 v46, v58, v58
    v_add_f32 v50, v50, v58
    v_fmac_f32 v47, v59, v59
    v_add_f32 v51, v51, v59
    v_fmac_f32 v44, v60, v60
    v_add_f32 v48, v48, v60
    v_fmac_f32 v45, v61, v61
    v_add_f32 v49, v49, v61
    v_fmac_f32 v46, v62, v62
    v_add_f32 v50, v50, v62
    v_fmac_f32 v47, v63, v63
    v_add_f32 v51, v51, v63
    v_permlane32_swap_b32 v48, v44
    v_permlane32_swap_b32 v49, v45
    v_permlane32_swap_b32 v50, v46
    v_permlane32_swap_b32 v51, v47
    v_add_f32 v48, v48, v44
    v_add_f32 v49, v49, v45
    v_add_f32 v50, v50, v46
    v_add_f32 v51, v51, v47
    v_permlane16_swap_b32 v48, v49
    s_nop 0
    v_permlane16_swap_b32 v50, v51
    v_add_f32 v48, v48, v49
    v_add_f32 v50, v50, v51
    s_nop 0
    v_add_f32_dpp v44, v48, v48 row_ror:8 row_mask:0xf bank_mask:0xf
    v_add_f32_dpp v46, v50, v50 row_ror:8 row_mask:0xf bank_mask:0xf
    v_cmp_eq_u32 vcc, 0, v17
    s_lshl_b32 s13, s7, 8
    s_add_u32 s13, s13, s101
    v_cndmask_b32 v44, v46, v44, vcc
    v_or_b32 v44, 1, v44
    buffer_store_dword v44, v18, s[84:87], s13 offen sc1
    s_waitcnt vmcnt(1)
    v_add_f32 v20, v20, v21
    v_add_f32 v22, v22, v23
    v_lshlrev_b32 v21, 2, v0
    v_add_u32 v21, 102400, v21
    v_add_f32 v20, v20, v22
    v_cmp_gt_u32 vcc, 224, v0
    v_mov_b32 v22, 105728
    s_nop 0
    v_cndmask_b32 v21, v22, v21, vcc
    ds_write_b32 v21, v20
    s_cmp_lg_u32 s3, 3
    s_cbranch_scc0 L_if_61
    s_add_u32 s14, s42, 106496
    s_cmp_eq_u32 s3, 3
    s_cselect_b32 s14, 0, s14
    s_add_u32 m0, s14, 0
    s_add_u32 s13, s40, 0
    s_waitcnt vmcnt(2)
    buffer_load_dwordx4 v7, s[84:87], s13 offen offset:0 sc1 lds
    s_waitcnt vmcnt(2)
    buffer_load_dwordx4 v7, s[84:87], s13 offen offset:1024 sc1 lds
    s_waitcnt vmcnt(2)
    buffer_load_dwordx4 v7, s[84:87], s13 offen offset:2048 sc1 lds
    s_waitcnt vmcnt(2)
    buffer_load_dwordx4 v7, s[84:87], s13 offen offset:3072 sc1 lds
    s_add_u32 m0, s14, 4096
    s_add_u32 s13, s41, 0
    s_waitcnt vmcnt(2)
    buffer_load_dwordx4 v7, s[84:87], s13 offen offset:0 sc1 lds
    s_waitcnt vmcnt(2)
    buffer_load_dwordx4 v7, s[84:87], s13 offen offset:1024 sc1 lds
    s_waitcnt vmcnt(2)
    buffer_load_dwordx4 v7, s[84:87], s13 offen offset:2048 sc1 lds
    s_waitcnt vmcnt(2)
    buffer_load_dwordx4 v7, s[84:87], s13 offen offset:3072 sc1 lds
L_if_61:
    s_waitcnt vmcnt(0)
    s_mov_b64 exec, 1
    ds_add_u32 v104, v106 offset:12
    s_mov_b64 exec, -1
    s_and_b32 s13, s3, 1
    s_mul_i32 s13, s13, 114688
    v_add_u32 v9, s13, v7
    s_sub_u32 s13, 114688, s13
    v_add_u32 v6, s13, v7
    s_lshr_b32 s13, s3, 1
    s_lshl_b32 s13, s13, 10
    v_add_u32 v0, 1024, v7
    v_add_u32 v10, s13, v0
    v_subrev_u32 v0, s13, v0
    s_sub_u32 s96, s96, 1024
    s_sub_u32 s97, s97, 1024
    s_add_u32 s13, s37, 0
    s_cmp_ge_u32 s13, 6
    s_cselect_b32 s99, 6, 0
    s_sub_u32 s13, s13, s99
    s_lshl_b32 s13, s13, 12
    s_add_u32 s13, s13, s97
    s_waitcnt vmcnt(2)
    buffer_load_dwordx4 v[112:115], v10, s[84:87], s13 offen offset:0 sc1
    s_waitcnt vmcnt(2)
    buffer_load_dwordx4 v[116:119], v0, s[84:87], s13 offen offset:1024 sc1
    s_waitcnt vmcnt(2)
    buffer_load_dwordx4 v[120:123], v10, s[84:87], s13 offen offset:2048 sc1
    s_waitcnt vmcnt(2)
    buffer_load_dwordx4 v[124:127], v0, s[84:87], s13 offen offset:3072 sc1
    s_add_u32 s13, s37, 1
    s_cmp_ge_u32 s13, 6
    s_cselect_b32 s99, 6, 0
    s_sub_u32 s13, s13, s99
    s_lshl_b32 s13, s13, 12
    s_add_u32 s13, s13, s97
    s_waitcnt vmcnt(2)
    buffer_load_dwordx4 v[128:131], v10, s[84:87], s13 offen offset:0 sc1
    s_waitcnt vmcnt(2)
    buffer_load_dwordx4 v[132:135], v0, s[84:87], s13 offen offset:1024 sc1
    s_waitcnt vmcnt(2)
    buffer_load_dwordx4 v[136:139], v10, s[84:87], s13 offen offset:2048 sc1
    s_waitcnt vmcnt(2)
    buffer_load_dwordx4 v[140:143], v0, s[84:87], s13 offen offset:3072 sc1
    v_mov_b32 v110, v27
    s_mov_b32 s98, 0
L_gs_62:
    ds_read_b32 v107, v104 offset:0
    s_add_u32 s98, s98, 1
    s_waitcnt lgkmcnt(0)
    v_cmp_ne_u32 vcc, 4, v107
    s_cbranch_vccz L_gd_63
    s_sleep 1
    s_cmp_lt_u32 s98, 0x1000000
    s_cbranch_scc1 L_gs_62
L_gd_63:
    s_cmp_eq_u32 s3, 3
    s_cbranch_scc0 L_if_64
    s_add_u32 s14, s42, 106496
    s_cmp_eq_u32 s3, 3
    s_cselect_b32 s14, 0, s14
    s_add_u32 m0, s14, 0
    s_add_u32 s13, s40, 0
    buffer_load_dwordx4 v7, s[84:87], s13 offen offset:0 sc1 lds
    buffer_load_dwordx4 v7, s[84:87], s13 offen offset:1024 sc1 lds
    buffer_load_dwordx4 v7, s[84:87], s13 offen offset:2048 sc1 lds
    buffer_load_dwordx4 v7, s[84:87], s13 offen offset:3072 sc1 lds
    s_add_u32 m0, s14, 4096
    s_add_u32 s13, s41, 0
    buffer_load_dwordx4 v7, s[84:87], s13 offen offset:0 sc1 lds
    buffer_load_dwordx4 v7, s[84:87], s13 offen offset:1024 sc1 lds
    buffer_load_dwordx4 v7, s[84:87], s13 offen offset:2048 sc1 lds
    buffer_load_dwordx4 v7, s[84:87], s13 offen offset:3072 sc1 lds
L_if_64:
    s_add_u32 s14, s42, 8192
    s_add_u32 m0, s14, 0
    s_add_u32 s13, s40, 32768
    buffer_load_dwordx4 v7, s[84:87], s13 offen offset:0 sc1 lds
    buffer_load_dwordx4 v7, s[84:87], s13 offen offset:1024 sc1 lds
    buffer_load_dwordx4 v7, s[84:87], s13 offen offset:2048 sc1 lds
    buffer_load_dwordx4 v7, s[84:87], s13 offen offset:3072 sc1 lds
    s_add_u32 m0, s14, 4096
    s_add_u32 s13, s41, 32768
    buffer_load_dwordx4 v7, s[84:87], s13 offen offset:0 sc1 lds
    buffer_load_dwordx4 v7, s[84:87], s13 offen offset:1024 sc1 lds
    buffer_load_dwordx4 v7, s[84:87], s13 offen offset:2048 sc1 lds
    buffer_load_dwordx4 v7, s[84:87], s13 offen offset:3072 sc1 lds
    buffer_load_dword v16, v110, s[84:87], s101 offen offset:0 sc1
    buffer_load_dword v17, v110, s[84:87], s101 offen offset:256 sc1
    buffer_load_dword v18, v110, s[84:87], s101 offen offset:512 sc1
    buffer_load_dword v19, v110, s[84:87], s101 offen offset:768 sc1
    buffer_load_dword v20, v110, s[84:87], s101 offen offset:1024 sc1
    buffer_load_dword v21, v110, s[84:87], s101 offen offset:1280 sc1
    buffer_load_dword v22, v110, s[84:87], s101 offen offset:1536 sc1
    buffer_load_dword v23, v110, s[84:87], s101 offen offset:1792 sc1
    buffer_load_dword v24, v110, s[84:87], s101 offen offset:2048 sc1
    buffer_load_dword v25, v110, s[84:87], s101 offen offset:2304 sc1
    buffer_load_dword v26, v110, s[84:87], s101 offen offset:2560 sc1
    buffer_load_dword v27, v110, s[84:87], s101 offen offset:2816 sc1
    buffer_load_dword v28, v110, s[84:87], s101 offen offset:3072 sc1
    buffer_load_dword v29, v110, s[84:87], s101 offen offset:3328 sc1
    buffer_load_dword v30, v110, s[84:87], s101 offen offset:3584 sc1
    buffer_load_dword v31, v110, s[84:87], s101 offen offset:3840 sc1
    s_add_u32 s14, s42, 40960
    s_add_u32 m0, s14, 0
    s_add_u32 s13, s40, 65536
    buffer_load_dwordx4 v7, s[84:87], s13 offen offset:0 sc1 lds
    buffer_load_dwordx4 v7, s[84:87], s13 offen offset:1024 sc1 lds
    buffer_load_dwordx4 v7, s[84:87], s13 offen offset:2048 sc1 lds
    buffer_load_dwordx4 v7, s[84:87], s13 offen offset:3072 sc1 lds
    s_add_u32 m0, s14, 4096
    s_add_u32 s13, s41, 65536
    buffer_load_dwordx4 v7, s[84:87], s13 offen offset:0 sc1 lds
    buffer_load_dwordx4 v7, s[84:87], s13 offen offset:1024 sc1 lds
    buffer_load_dwordx4 v7, s[84:87], s13 offen offset:2048 sc1 lds
    buffer_load_dwordx4 v7, s[84:87], s13 offen offset:3072 sc1 lds
    s_waitcnt vmcnt(24)
    s_mov_b64 exec, 1
    ds_add_u32 v104, v106 offset:16
    s_mov_b64 exec, -1
    s_setprio 2
    s_waitcnt vmcnt(8)
    s_mov_b32 s98, 0
L_sg:
    v_and_b32 v108, v16, v17
    v_bitop3_b32 v108, v108, v18, v19 bitop3:0x80
    v_bitop3_b32 v108, v108, v20, v21 bitop3:0x80
    v_bitop3_b32 v108, v108, v22, v23 bitop3:0x80
    v_bitop3_b32 v108, v108, v24, v25 bitop3:0x80
    v_bitop3_b32 v108, v108, v26, v27 bitop3:0x80
    v_bitop3_b32 v108, v108, v28, v29 bitop3:0x80
    v_bitop3_b32 v108, v108, v30, v31 bitop3:0x80
    v_and_b32 v108, 1, v108
    v_cmp_eq_u32 vcc, 0, v108
    s_cbranch_vccz L_sgok
    s_sleep 1
    buffer_load_dword v16, v110, s[84:87], s101 offen offset:0 sc1
    buffer_load_dword v17, v110, s[84:87], s101 offen offset:256 sc1
    buffer_load_dword v18, v110, s[84:87], s101 offen offset:512 sc1
    buffer_load_dword v19, v110, s[84:87], s101 offen offset:768 sc1
    buffer_load_dword v20, v110, s[84:87], s101 offen offset:1024 sc1
    buffer_load_dword v21, v110, s[84:87], s101 offen offset:1280 sc1
    buffer_load_dword v22, v110, s[84:87], s101 offen offset:1536 sc1
    buffer_load_dword v23, v110, s[84:87], s101 offen offset:1792 sc1
    buffer_load_dword v24, v110, s[84:87], s101 offen offset:2048 sc1
    buffer_load_dword v25, v110, s[84:87], s101 offen offset:2304 sc1
    buffer_load_dword v26, v110, s[84:87], s101 offen offset:2560 sc1
    buffer_load_dword v27, v110, s[84:87], s101 offen offset:2816 sc1
    buffer_load_dword v28, v110, s[84:87], s101 offen offset:3072 sc1
    buffer_load_dword v29, v110, s[84:87], s101 offen offset:3328 sc1
    buffer_load_dword v30, v110, s[84:87], s101 offen offset:3584 sc1
    buffer_load_dword v31, v110, s[84:87], s101 offen offset:3840 sc1
    s_add_u32 s98, s98, 1
    s_waitcnt vmcnt(0)
    s_cmp_lt_u32 s98, 0x40000
    s_cbranch_scc1 L_sg
L_sgok:
    v_add_f32 v16, v16, v17
    v_add_f32 v18, v18, v19
    v_add_f32 v20, v20, v21
    v_add_f32 v22, v22, v23
    v_add_f32 v24, v24, v25
    v_add_f32 v26, v26, v27
    v_add_f32 v28, v28, v29
    v_add_f32 v30, v30, v31
    v_add_f32 v16, v16, v18
    v_add_f32 v20, v20, v22
    v_add_f32 v24, v24, v26
    v_add_f32 v28, v28, v30
    v_add_f32 v16, v16, v20
    v_add_f32 v24, v24, v28
    v_add_f32 v16, v16, v24
    v_mov_b32 v11, v16
    v_mov_b32 v12, v16
    s_nop 1
    v_permlane32_swap_b32 v11, v12
    v_mul_f32 v11, 0x3b000000, v11
    v_mul_f32 v12, 0x3b000000, v12
    v_fma_f32 v12, -v11, v11, v12
    v_max_f32 v12, 0, v12
    v_cvt_pk_bf16_f32 v5, v11, v12
    v_lshlrev_b32 v11, 16, v5
    v_and_b32 v12, 0xffff0000, v5
    v_add_f32 v12, 0x3727c5ac, v12
    v_cvt_pk_bf16_f32 v5, v12, v12
    v_and_b32 v12, 0xffff0000, v5
    v_sqrt_f32 v12, v12
    s_nop 0
    v_cvt_pk_bf16_f32 v5, v12, v12
    v_and_b32 v12, 0xffff0000, v5
    v_rcp_f32 v5, v12
    v_sub_f32 v11, 0, v11
    v_mul_f32 v12, v12, v12
    v_mul_f32 v5, 0xbfb8aa3b, v5
    s_mul_i32 s13, s3, 768
    s_add_u32 s13, s13, 103424
    v_add_u32 v109, s13, v110
    ds_write_b32 v109, v11 offset:0
    ds_write_b32 v109, v12 offset:256
    ds_write_b32 v109, v5 offset:512
    s_waitcnt lgkmcnt(0)
    s_mov_b64 exec, 1
    ds_add_u32 v104, v106 offset:28
    s_mov_b64 exec, -1
    s_waitcnt vmcnt(0)
    s_mov_b64 exec, 1
    ds_add_u32 v104, v106 offset:20
    s_mov_b64 exec, -1
    s_add_u32 s13, s37, 2
    s_cmp_ge_u32 s13, 6
    s_cselect_b32 s99, 6, 0
    s_sub_u32 s13, s13, s99
    s_lshl_b32 s13, s13, 12
    s_add_u32 s13, s13, s97
    buffer_load_dwordx4 v[144:147], v10, s[84:87], s13 offen offset:0 sc1
    buffer_load_dwordx4 v[148:151], v0, s[84:87], s13 offen offset:1024 sc1
    buffer_load_dwordx4 v[152:155], v10, s[84:87], s13 offen offset:2048 sc1
    buffer_load_dwordx4 v[156:159], v0, s[84:87], s13 offen offset:3072 sc1
    s_add_u32 s13, s37, 3
    s_cmp_ge_u32 s13, 6
    s_cselect_b32 s99, 6, 0
    s_sub_u32 s13, s13, s99
    s_lshl_b32 s13, s13, 12
    s_add_u32 s13, s13, s97
    buffer_load_dwordx4 v[160:163], v10, s[84:87], s13 offen offset:0 sc1
    buffer_load_dwordx4 v[164:167], v0, s[84:87], s13 offen offset:1024 sc1
    buffer_load_dwordx4 v[168:171], v10, s[84:87], s13 offen offset:2048 sc1
    buffer_load_dwordx4 v[172:175], v0, s[84:87], s13 offen offset:3072 sc1
    s_mov_b32 s98, 0
L_gs_65:
    ds_read_b32 v107, v104 offset:12
    s_add_u32 s98, s98, 1
    s_waitcnt lgkmcnt(0)
    v_cmp_ne_u32 vcc, 4, v107
    s_cbranch_vccz L_gd_66
    s_sleep 1
    s_cmp_lt_u32 s98, 0x1000000
    s_cbranch_scc1 L_gs_65
L_gd_66:
    ds_read_b128 v[80:83], v3 offset:0
    ds_read_b128 v[84:87], v3 offset:32
    ds_read_b128 v[88:91], v3 offset:64
    ds_read_b128 v[92:95], v3 offset:96
    ds_read_b128 v[32:35], v3 offset:128
    ds_read_b128 v[36:39], v3 offset:160
    ds_read_b128 v[40:43], v3 offset:192
    ds_read_b128 v[44:47], v3 offset:224
    s_mov_b32 s98, 0
L_gs_67:
    ds_read_b32 v107, v105 offset:32
    s_add_u32 s98, s98, 1
    s_waitcnt lgkmcnt(0)
    v_cmp_gt_u32 vcc, 1, v107
    s_cbranch_vccz L_gd_68
    s_sleep 1
    s_cmp_lt_u32 s98, 0x1000000
    s_cbranch_scc1 L_gs_67
L_gd_68:
    ds_read_b128 v[48:51], v4 offset:0
    ds_read_b128 v[52:55], v4 offset:1024
    ds_read_b128 v[56:59], v4 offset:2048
    ds_read_b128 v[60:63], v4 offset:3072
    s_waitcnt lgkmcnt(0)
    v_fmac_f32 v48, v11, v80
    v_fmac_f32 v49, v11, v81
    v_fmac_f32 v50, v11, v82
    v_fmac_f32 v51, v11, v83
    v_fmac_f32 v52, v11, v84
    v_fmac_f32 v53, v11, v85
    v_fmac_f32 v54, v11, v86
    v_fmac_f32 v55, v11, v87
    v_mul_f32 v96, v5, v48
    v_mul_f32 v97, v5, v49
    v_mul_f32 v98, v5, v50
    v_mul_f32 v99, v5, v51
    v_mul_f32 v100, v5, v52
    v_mul_f32 v101, v5, v53
    v_mul_f32 v102, v5, v54
    v_mul_f32 v103, v5, v55
    v_exp_f32 v96, v96
    v_fmac_f32 v56, v11, v88
    v_exp_f32 v97, v97
    v_fmac_f32 v57, v11, v89
    v_exp_f32 v98, v98
    v_fmac_f32 v58, v11, v90
    v_exp_f32 v99, v99
    v_fmac_f32 v59, v11, v91
    v_exp_f32 v100, v100
    v_fmac_f32 v60, v11, v92
    v_exp_f32 v101, v101
    v_fmac_f32 v61, v11, v93
    v_exp_f32 v102, v102
    v_fmac_f32 v62, v11, v94
    v_exp_f32 v103, v103
    v_fmac_f32 v63, v11, v95
    v_fma_f32 v96, v96, v12, v12
    v_fma_f32 v97, v97, v12, v12
    s_add_u32 s13, s37, 4
    s_cmp_ge_u32 s13, 6
    s_cselect_b32 s99, 6, 0
    s_sub_u32 s13, s13, s99
    s_lshl_b32 s13, s13, 12
    s_add_u32 s13, s13, s97
    buffer_load_dwordx4 v[176:179], v10, s[84:87], s13 offen offset:0 sc1
    buffer_load_dwordx4 v[180:183], v0, s[84:87], s13 offen offset:1024 sc1
    buffer_load_dwordx4 v[184:187], v10, s[84:87], s13 offen offset:2048 sc1
    buffer_load_dwordx4 v[188:191], v0, s[84:87], s13 offen offset:3072 sc1
    v_fma_f32 v98, v98, v12, v12
    v_fma_f32 v99, v99, v12, v12
    v_fma_f32 v100, v100, v12, v12
    v_fma_f32 v101, v101, v12, v12
    v_fma_f32 v102, v102, v12, v12
    v_fma_f32 v103, v103, v12, v12
    v_rcp_f32 v96, v96
    v_mul_f32 v48, v48, v56
    v_rcp_f32 v97, v97
    v_mul_f32 v49, v49, v57
    v_rcp_f32 v98, v98
    v_mul_f32 v50, v50, v58
    v_rcp_f32 v99, v99
    v_mul_f32 v51, v51, v59
    v_rcp_f32 v100, v100
    v_mul_f32 v52, v52, v60
    v_rcp_f32 v101, v101
    s_add_u32 s13, s37, 5
    s_cmp_ge_u32 s13, 6
    s_cselect_b32 s99, 6, 0
    s_sub_u32 s13, s13, s99
    s_lshl_b32 s13, s13, 12
    s_add_u32 s13, s13, s97
    buffer_load_dwordx4 v[192:195], v10, s[84:87], s13 offen offset:0 sc1
    buffer_load_dwordx4 v[196:199], v0, s[84:87], s13 offen offset:1024 sc1
    buffer_load_dwordx4 v[200:203], v10, s[84:87], s13 offen offset:2048 sc1
    buffer_load_dwordx4 v[204:207], v0, s[84:87], s13 offen offset:3072 sc1
    v_mul_f32 v53, v53, v61
    v_rcp_f32 v102, v102
    v_mul_f32 v54, v54, v62
    v_rcp_f32 v103, v103
    v_mul_f32 v55, v55, v63
    v_mul_f32 v48, v48, v96
    v_mul_f32 v49, v49, v97
    v_mul_f32 v50, v50, v98
    v_mul_f32 v51, v51, v99
    v_mul_f32 v52, v52, v100
    v_mul_f32 v53, v53, v101
    v_mul_f32 v54, v54, v102
    v_mul_f32 v55, v55, v103
    v_cvt_pk_bf16_f32 v56, v48, v49
    v_cvt_pk_bf16_f32 v57, v50, v51
    v_cvt_pk_bf16_f32 v58, v52, v53
    v_cvt_pk_bf16_f32 v59, v54, v55
    buffer_store_dwordx4 v[56:59], v7, s[84:87], s89 offen offset:0 sc1
    ds_read_b128 v[80:83], v3 offset:256
    ds_read_b128 v[84:87], v3 offset:288
    ds_read_b128 v[88:91], v3 offset:320
    ds_read_b128 v[92:95], v3 offset:352
    s_mov_b32 s98, 0
L_gs_69:
    ds_read_b32 v107, v105 offset:32
    s_add_u32 s98, s98, 1
    s_waitcnt lgkmcnt(0)
    v_cmp_gt_u32 vcc, 2, v107
    s_cbranch_vccz L_gd_70
    s_sleep 1
    s_cmp_lt_u32 s98, 0x1000000
    s_cbranch_scc1 L_gs_69
L_gd_70:
    ds_read_b128 v[64:67], v4 offset:4096
    ds_read_b128 v[68:71], v4 offset:5120
    ds_read_b128 v[72:75], v4 offset:6144
    ds_read_b128 v[76:79], v4 offset:7168
    s_waitcnt lgkmcnt(0)
    s_add_u32 s14, s42, 131072
    s_add_u32 m0, s14, 0
    s_add_u32 s13, s40, 98304
    buffer_load_dwordx4 v7, s[84:87], s13 offen offset:0 sc1 lds
    buffer_load_dwordx4 v7, s[84:87], s13 offen offset:1024 sc1 lds
    buffer_load_dwordx4 v7, s[84:87], s13 offen offset:2048 sc1 lds
    buffer_load_dwordx4 v7, s[84:87], s13 offen offset:3072 sc1 lds
    s_add_u32 m0, s14, 4096
    s_add_u32 s13, s41, 98304
    buffer_load_dwordx4 v7, s[84:87], s13 offen offset:0 sc1 lds
    buffer_load_dwordx4 v7, s[84:87], s13 offen offset:1024 sc1 lds
    buffer_load_dwordx4 v7, s[84:87], s13 offen offset:2048 sc1 lds
    buffer_load_dwordx4 v7, s[84:87], s13 offen offset:3072 sc1 lds
    v_fmac_f32 v64, v11, v32
    v_fmac_f32 v65, v11, v33
    v_fmac_f32 v66, v11, v34
    v_fmac_f32 v67, v11, v35
    v_fmac_f32 v68, v11, v36
    v_fmac_f32 v69, v11, v37
    v_fmac_f32 v70, v11, v38
    v_fmac_f32 v71, v11, v39
    v_mul_f32 v96, v5, v64
    v_mul_f32 v97, v5, v65
    v_mul_f32 v98, v5, v66
    v_mul_f32 v99, v5, v67
    v_mul_f32 v100, v5, v68
    v_mul_f32 v101, v5, v69
    v_mul_f32 v102, v5, v70
    v_mul_f32 v103, v5, v71
    v_exp_f32 v96, v96
    v_fmac_f32 v72, v11, v40
    v_exp_f32 v97, v97
    v_fmac_f32 v73, v11, v41
    v_exp_f32 v98, v98
    v_fmac_f32 v74, v11, v42
    v_exp_f32 v99, v99
    v_fmac_f32 v75, v11, v43
    v_exp_f32 v100, v100
    v_fmac_f32 v76, v11, v44
    v_exp_f32 v101, v101
    v_fmac_f32 v77, v11, v45
    v_exp_f32 v102, v102
    v_fmac_f32 v78, v11, v46
    v_exp_f32 v103, v103
    v_fmac_f32 v79, v11, v47
    v_fma_f32 v96, v96, v12, v12
    v_fma_f32 v97, v97, v12, v12
    s_add_u32 s13, s36, 0
    s_and_b32 s13, s13, 3
    s_lshl_b32 s13, s13, 13
    s_add_u32 s13, s13, s96
    buffer_load_dwordx4 v[208:211], v10, s[84:87], s13 offen offset:0 sc1
    buffer_load_dwordx4 v[212:215], v0, s[84:87], s13 offen offset:1024 sc1
    buffer_load_dwordx4 v[216:219], v10, s[84:87], s13 offen offset:2048 sc1
    buffer_load_dwordx4 v[220:223], v0, s[84:87], s13 offen offset:3072 sc1
    v_fma_f32 v98, v98, v12, v12
    v_fma_f32 v99, v99, v12, v12
    v_fma_f32 v100, v100, v12, v12
    v_fma_f32 v101, v101, v12, v12
    v_fma_f32 v102, v102, v12, v12
    v_fma_f32 v103, v103, v12, v12
    v_rcp_f32 v96, v96
    v_mul_f32 v64, v64, v72
    v_rcp_f32 v97, v97
    v_mul_f32 v65, v65, v73
    v_rcp_f32 v98, v98
    v_mul_f32 v66, v66, v74
    v_rcp_f32 v99, v99
    v_mul_f32 v67, v67, v75
    v_rcp_f32 v100, v100
    v_mul_f32 v68, v68, v76
    v_rcp_f32 v101, v101
    s_add_u32 s13, s36, 1
    s_and_b32 s13, s13, 3
    s_lshl_b32 s13, s13, 13
    s_add_u32 s13, s13, s96
    buffer_load_dwordx4 v[224:227], v10, s[84:87], s13 offen offset:0 sc1
    buffer_load_dwordx4 v[228:231], v0, s[84:87], s13 offen offset:1024 sc1
    buffer_load_dwordx4 v[232:235], v10, s[84:87], s13 offen offset:2048 sc1
    buffer_load_dwordx4 v[236:239], v0, s[84:87], s13 offen offset:3072 sc1
    v_mul_f32 v69, v69, v77
    v_rcp_f32 v102, v102
    v_mul_f32 v70, v70, v78
    v_rcp_f32 v103, v103
    v_mul_f32 v71, v71, v79
    v_mul_f32 v64, v64, v96
    v_mul_f32 v65, v65, v97
    v_mul_f32 v66, v66, v98
    v_mul_f32 v67, v67, v99
    v_mul_f32 v68, v68, v100
    v_mul_f32 v69, v69, v101
    v_mul_f32 v70, v70, v102
    v_mul_f32 v71, v71, v103
    v_cvt_pk_bf16_f32 v72, v64, v65
    v_cvt_pk_bf16_f32 v73, v66, v67
    v_cvt_pk_bf16_f32 v74, v68, v69
    v_cvt_pk_bf16_f32 v75, v70, v71
    buffer_store_dwordx4 v[72:75], v7, s[84:87], s89 offen offset:1024 sc1
    s_mov_b32 s98, 0
L_gs_71:
    ds_read_b32 v107, v105 offset:32
    s_add_u32 s98, s98, 1
    s_waitcnt lgkmcnt(0)
    v_cmp_gt_u32 vcc, 3, v107
    s_cbranch_vccz L_gd_72
    s_sleep 1
    s_cmp_lt_u32 s98, 0x1000000
    s_cbranch_scc1 L_gs_71
L_gd_72:
    ds_read_b128 v[16:19], v14 offset:8192
    ds_read_b128 v[20:23], v14 offset:9216
    ds_read_b128 v[24:27], v14 offset:10240
    ds_read_b128 v[28:31], v14 offset:11264
    s_waitcnt lgkmcnt(0)
    v_fmac_f32 v16, v11, v80
    v_fmac_f32 v17, v11, v81
    v_fmac_f32 v18, v11, v82
    v_fmac_f32 v19, v11, v83
    v_fmac_f32 v20, v11, v84
    v_fmac_f32 v21, v11, v85
    v_fmac_f32 v22, v11, v86
    v_fmac_f32 v23, v11, v87
    v_mul_f32 v96, v5, v16
    v_mul_f32 v97, v5, v17
    v_mul_f32 v98, v5, v18
    v_mul_f32 v99, v5, v19
    v_mul_f32 v100, v5, v20
    v_mul_f32 v101, v5, v21
    v_mul_f32 v102, v5, v22
    v_mul_f32 v103, v5, v23
    v_exp_f32 v96, v96
    v_fmac_f32 v24, v11, v88
    v_exp_f32 v97, v97
    v_fmac_f32 v25, v11, v89
    v_exp_f32 v98, v98
    v_fmac_f32 v26, v11, v90
    v_exp_f32 v99, v99
    v_fmac_f32 v27, v11, v91
    v_exp_f32 v100, v100
    v_fmac_f32 v28, v11, v92
    s_add_u32 s13, s36, 2
    s_and_b32 s13, s13, 3
    s_lshl_b32 s13, s13, 13
    s_add_u32 s13, s13, s96
    buffer_load_dwordx4 v[240:243], v10, s[84:87], s13 offen offset:0 sc1
    buffer_load_dwordx4 v[244:247], v0, s[84:87], s13 offen offset:1024 sc1
    buffer_load_dwordx4 v[248:251], v10, s[84:87], s13 offen offset:2048 sc1
    buffer_load_dwordx4 v[252:255], v0, s[84:87], s13 offen offset:3072 sc1
    v_exp_f32 v101, v101
    v_fmac_f32 v29, v11, v93
    v_exp_f32 v102, v102
    v_fmac_f32 v30, v11, v94
    v_exp_f32 v103, v103
    v_fmac_f32 v31, v11, v95
    v_fma_f32 v96, v96, v12, v12
    v_fma_f32 v97, v97, v12, v12
    v_fma_f32 v98, v98, v12, v12
    v_fma_f32 v99, v99, v12, v12
    v_fma_f32 v100, v100, v12, v12
    v_fma_f32 v101, v101, v12, v12
    v_fma_f32 v102, v102, v12, v12
    v_fma_f32 v103, v103, v12, v12
    v_rcp_f32 v96, v96
    v_mul_f32 v16, v16, v24
    v_rcp_f32 v97, v97
    v_mul_f32 v17, v17, v25
    v_rcp_f32 v98, v98
    v_mul_f32 v18, v18, v26
    v_rcp_f32 v99, v99
    v_mul_f32 v19, v19, v27
    v_rcp_f32 v100, v100
    v_mul_f32 v20, v20, v28
    v_rcp_f32 v101, v101
    v_mul_f32 v21, v21, v29
    s_waitcnt vmcnt(13)
    s_mov_b64 exec, 1
    ds_add_u32 v104, v106 offset:24
    s_mov_b64 exec, -1
    v_rcp_f32 v102, v102
    v_mul_f32 v22, v22, v30
    v_rcp_f32 v103, v103
    v_mul_f32 v23, v23, v31
    v_mul_f32 v16, v16, v96
    v_mul_f32 v17, v17, v97
    v_mul_f32 v18, v18, v98
    v_mul_f32 v19, v19, v99
    v_mul_f32 v20, v20, v100
    v_mul_f32 v21, v21, v101
    v_mul_f32 v22, v22, v102
    v_mul_f32 v23, v23, v103
    v_cvt_pk_bf16_f32 v24, v16, v17
    v_cvt_pk_bf16_f32 v25, v18, v19
    v_cvt_pk_bf16_f32 v26, v20, v21
    v_cvt_pk_bf16_f32 v27, v22, v23
    buffer_store_dwordx4 v[24:27], v7, s[84:87], s89 offen offset:2048 sc1
    s_setprio 0
    s_waitcnt vmcnt(0)
    s_atomic_add s16, s[84:85], s38
    s_mov_b32 s98, 0
L_gs_73:
    ds_read_b32 v107, v104 offset:8
    s_add_u32 s98, s98, 1
    s_waitcnt lgkmcnt(0)
    v_cmp_ne_u32 vcc, 4, v107
    s_cbranch_vccz L_gd_74
    s_sleep 1
    s_cmp_lt_u32 s98, 0x1000000
    s_cbranch_scc1 L_gs_73
L_gd_74:
    s_add_u32 s13, s36, 3
    s_and_b32 s13, s13, 3
    s_lshl_b32 s13, s13, 13
    s_add_u32 s13, s13, s96
    s_add_u32 m0, s43, 73728
    s_nop 0
    buffer_load_dwordx4 v10, s[84:87], s13 offen offset:0 sc1 lds
    buffer_load_dwordx4 v0, s[84:87], s13 offen offset:1024 sc1 lds
    buffer_load_dwordx4 v10, s[84:87], s13 offen offset:2048 sc1 lds
    buffer_load_dwordx4 v0, s[84:87], s13 offen offset:3072 sc1 lds
    s_add_u32 s13, s36, 0
    s_and_b32 s13, s13, 3
    s_lshl_b32 s13, s13, 13
    s_add_u32 s13, s13, s96
    s_add_u32 s13, s13, 4096
    s_add_u32 m0, s43, 106496
    s_nop 0
    buffer_load_dwordx4 v10, s[84:87], s13 offen offset:0 sc1 lds
    buffer_load_dwordx4 v0, s[84:87], s13 offen offset:1024 sc1 lds
    buffer_load_dwordx4 v10, s[84:87], s13 offen offset:2048 sc1 lds
    buffer_load_dwordx4 v0, s[84:87], s13 offen offset:3072 sc1 lds
    s_add_u32 s13, s36, 1
    s_and_b32 s13, s13, 3
    s_lshl_b32 s13, s13, 13
    s_add_u32 s13, s13, s96
    s_add_u32 s13, s13, 4096
    s_add_u32 m0, s43, 0
    s_nop 0
    buffer_load_dwordx4 v10, s[84:87], s13 offen offset:0 sc1 lds
    buffer_load_dwordx4 v0, s[84:87], s13 offen offset:1024 sc1 lds
    buffer_load_dwordx4 v10, s[84:87], s13 offen offset:2048 sc1 lds
    buffer_load_dwordx4 v0, s[84:87], s13 offen offset:3072 sc1 lds
    s_add_u32 s13, s36, 2
    s_and_b32 s13, s13, 3
    s_lshl_b32 s13, s13, 13
    s_add_u32 s13, s13, s96
    s_add_u32 s13, s13, 4096
    s_add_u32 m0, s43, 16384
    s_nop 0
    buffer_load_dwordx4 v10, s[84:87], s13 offen offset:0 sc1 lds
    buffer_load_dwordx4 v0, s[84:87], s13 offen offset:1024 sc1 lds
    buffer_load_dwordx4 v10, s[84:87], s13 offen offset:2048 sc1 lds
    buffer_load_dwordx4 v0, s[84:87], s13 offen offset:3072 sc1 lds
    s_mov_b32 s98, 0
L_poll_75:
    s_mov_b32 s99, 0
    s_atomic_add s99, s[84:85], s39 glc
    s_add_u32 s98, s98, 1
    s_waitcnt lgkmcnt(0)
    s_cmp_ge_u32 s99, 8
    s_cbranch_scc1 L_pdone_76
    s_sleep 2
    s_cmp_lt_u32 s98, 0x100000
    s_cbranch_scc1 L_poll_75
L_pdone_76:
    s_add_u32 s15, s37, 0
    s_cmp_ge_u32 s15, 6
    s_cselect_b32 s99, 6, 0
    s_sub_u32 s15, s15, s99
    s_lshl_b32 s15, s15, 11
    s_add_u32 s15, s15, s91
    buffer_load_dwordx4 v[16:19], v9, s[84:87], s15 offen offset:0 sc1
    buffer_load_dwordx4 v[20:23], v6, s[84:87], s15 offen offset:0 sc1
    buffer_load_dwordx4 v[24:27], v9, s[84:87], s15 offen offset:1024 sc1
    buffer_load_dwordx4 v[28:31], v6, s[84:87], s15 offen offset:1024 sc1
    s_add_u32 s15, s37, 1
    s_cmp_ge_u32 s15, 6
    s_cselect_b32 s99, 6, 0
    s_sub_u32 s15, s15, s99
    s_lshl_b32 s15, s15, 11
    s_add_u32 s15, s15, s91
    buffer_load_dwordx4 v[32:35], v9, s[84:87], s15 offen offset:0 sc1
    buffer_load_dwordx4 v[36:39], v6, s[84:87], s15 offen offset:0 sc1
    buffer_load_dwordx4 v[40:43], v9, s[84:87], s15 offen offset:1024 sc1
    buffer_load_dwordx4 v[44:47], v6, s[84:87], s15 offen offset:1024 sc1
    s_waitcnt vmcnt(6)
    v_mfma_f32_32x32x16_bf16 v[48:63], v[112:115], v[16:19], 0
    v_mfma_f32_32x32x16_bf16 v[80:95], v[116:119], v[16:19], 0
    v_mfma_f32_32x32x16_bf16 v[64:79], v[112:115], v[20:23], 0
    v_mfma_f32_32x32x16_bf16 v[96:111], v[116:119], v[20:23], 0
    s_waitcnt vmcnt(4)
    v_mfma_f32_32x32x16_bf16 v[48:63], v[120:123], v[24:27], v[48:63]
    s_add_u32 s15, s37, 2
    s_cmp_ge_u32 s15, 6
    s_cselect_b32 s99, 6, 0
    s_sub_u32 s15, s15, s99
    s_lshl_b32 s15, s15, 11
    s_add_u32 s15, s15, s91
    buffer_load_dwordx4 v[16:19], v9, s[84:87], s15 offen offset:0 sc1
    v_mfma_f32_32x32x16_bf16 v[80:95], v[124:127], v[24:27], v[80:95]
    buffer_load_dwordx4 v[20:23], v6, s[84:87], s15 offen offset:0 sc1
    v_mfma_f32_32x32x16_bf16 v[64:79], v[120:123], v[28:31], v[64:79]
    buffer_load_dwordx4 v[112:115], v9, s[84:87], s15 offen offset:1024 sc1
    v_mfma_f32_32x32x16_bf16 v[96:111], v[124:127], v[28:31], v[96:111]
    buffer_load_dwordx4 v[116:119], v6, s[84:87], s15 offen offset:1024 sc1
    s_waitcnt vmcnt(6)
    v_mfma_f32_32x32x16_bf16 v[48:63], v[128:131], v[32:35], v[48:63]
    s_add_u32 s15, s37, 3
    s_cmp_ge_u32 s15, 6
    s_cselect_b32 s99, 6, 0
    s_sub_u32 s15, s15, s99
    s_lshl_b32 s15, s15, 11
    s_add_u32 s15, s15, s91
    buffer_load_dwordx4 v[24:27], v9, s[84:87], s15 offen offset:0 sc1
    v_mfma_f32_32x32x16_bf16 v[80:95], v[132:135], v[32:35], v[80:95]
    buffer_load_dwordx4 v[28:31], v6, s[84:87], s15 offen offset:0 sc1
    v_mfma_f32_32x32x16_bf16 v[64:79], v[128:131], v[36:39], v[64:79]
    buffer_load_dwordx4 v[120:123], v9, s[84:87], s15 offen offset:1024 sc1
    v_mfma_f32_32x32x16_bf16 v[96:111], v[132:135], v[36:39], v[96:111]
    buffer_load_dwordx4 v[124:127], v6, s[84:87], s15 offen offset:1024 sc1
    s_waitcnt vmcnt(8)
    v_mfma_f32_32x32x16_bf16 v[48:63], v[136:139], v[40:43], v[48:63]
    s_add_u32 s15, s37, 4
    s_cmp_ge_u32 s15, 6
    s_cselect_b32 s99, 6, 0
    s_sub_u32 s15, s15, s99
    s_lshl_b32 s15, s15, 11
    s_add_u32 s15, s15, s91
    buffer_load_dwordx4 v[32:35], v9, s[84:87], s15 offen offset:0 sc1
    v_mfma_f32_32x32x16_bf16 v[80:95], v[140:143], v[40:43], v[80:95]
    buffer_load_dwordx4 v[36:39], v6, s[84:87], s15 offen offset:0 sc1
    v_mfma_f32_32x32x16_bf16 v[64:79], v[136:139], v[44:47], v[64:79]
    v_mfma_f32_32x32x16_bf16 v[96:111], v[140:143], v[44:47], v[96:111]
    s_add_u32 s39, s39, 256
    s_mov_b32 s101, 0
    s_atomic_add s101, s[84:85], s39 glc
    s_waitcnt vmcnt(8)
    v_mfma_f32_32x32x16_bf16 v[48:63], v[144:147], v[16:19], v[48:63]
    buffer_load_dwordx4 v[128:131], v9, s[84:87], s15 offen offset:1024 sc1
    v_mfma_f32_32x32x16_bf16 v[80:95], v[148:151], v[16:19], v[80:95]
    buffer_load_dwordx4 v[132:135], v6, s[84:87], s15 offen offset:1024 sc1
    v_mfma_f32_32x32x16_bf16 v[64:79], v[144:147], v[20:23], v[64:79]
    v_mfma_f32_32x32x16_bf16 v[96:111], v[148:151], v[20:23], v[96:111]
    s_waitcnt vmcnt(8)
    v_mfma_f32_32x32x16_bf16 v[48:63], v[152:155], v[112:115], v[48:63]
    s_add_u32 s15, s37, 5
    s_cmp_ge_u32 s15, 6
    s_cselect_b32 s99, 6, 0
    s_sub_u32 s15, s15, s99
    s_lshl_b32 s15, s15, 11
    s_add_u32 s15, s15, s91
    buffer_load_dwordx4 v[40:43], v9, s[84:87], s15 offen offset:0 sc1
    v_mfma_f32_32x32x16_bf16 v[80:95], v[156:159], v[112:115], v[80:95]
    buffer_load_dwordx4 v[44:47], v6, s[84:87], s15 offen offset:0 sc1
    v_mfma_f32_32x32x16_bf16 v[64:79], v[152:155], v[116:119], v[64:79]
    v_mfma_f32_32x32x16_bf16 v[96:111], v[156:159], v[116:119], v[96:111]
    s_waitcnt vmcnt(8)
    v_mfma_f32_32x32x16_bf16 v[48:63], v[160:163], v[24:27], v[48:63]
    buffer_load_dwordx4 v[136:139], v9, s[84:87], s15 offen offset:1024 sc1
    v_mfma_f32_32x32x16_bf16 v[80:95], v[164:167], v[24:27], v[80:95]
    buffer_load_dwordx4 v[140:143], v6, s[84:87], s15 offen offset:1024 sc1
    v_mfma_f32_32x32x16_bf16 v[64:79], v[160:163], v[28:31], v[64:79]
    v_mfma_f32_32x32x16_bf16 v[96:111], v[164:167], v[28:31], v[96:111]
    s_waitcnt lgkmcnt(0)
    s_cmp_lt_u32 s101, 8
    s_cbranch_scc0 L_if_77
    s_mov_b32 s98, 0
L_poll_78:
    s_mov_b32 s99, 0
    s_atomic_add s99, s[84:85], s39 glc
    s_add_u32 s98, s98, 1
    s_waitcnt lgkmcnt(0)
    s_cmp_ge_u32 s99, 8
    s_cbranch_scc1 L_pdone_79
    s_sleep 2
    s_cmp_lt_u32 s98, 0x100000
    s_cbranch_scc1 L_poll_78
L_pdone_79:
L_if_77:
    s_waitcnt vmcnt(8)
    v_mfma_f32_32x32x16_bf16 v[48:63], v[168:171], v[120:123], v[48:63]
    s_add_u32 s15, s36, 0
    s_and_b32 s15, s15, 3
    s_lshl_b32 s15, s15, 12
    s_add_u32 s15, s15, s90
    buffer_load_dwordx4 v[16:19], v9, s[84:87], s15 offen offset:0 sc1
    v_mfma_f32_32x32x16_bf16 v[80:95], v[172:175], v[120:123], v[80:95]
    buffer_load_dwordx4 v[20:23], v6, s[84:87], s15 offen offset:0 sc1
    v_mfma_f32_32x32x16_bf16 v[64:79], v[168:171], v[124:127], v[64:79]
    v_mfma_f32_32x32x16_bf16 v[96:111], v[172:175], v[124:127], v[96:111]
    s_waitcnt vmcnt(8)
    v_mfma_f32_32x32x16_bf16 v[48:63], v[176:179], v[32:35], v[48:63]
    buffer_load_dwordx4 v[144:147], v9, s[84:87], s15 offen offset:1024 sc1
    v_mfma_f32_32x32x16_bf16 v[80:95], v[180:183], v[32:35], v[80:95]
    buffer_load_dwordx4 v[148:151], v6, s[84:87], s15 offen offset:1024 sc1
    v_mfma_f32_32x32x16_bf16 v[64:79], v[176:179], v[36:39], v[64:79]
    v_mfma_f32_32x32x16_bf16 v[96:111], v[180:183], v[36:39], v[96:111]
    s_waitcnt vmcnt(8)
    v_mfma_f32_32x32x16_bf16 v[48:63], v[184:187], v[128:131], v[48:63]
    s_add_u32 s15, s36, 1
    s_and_b32 s15, s15, 3
    s_lshl_b32 s15, s15, 12
    s_add_u32 s15, s15, s90
    buffer_load_dwordx4 v[112:115], v9, s[84:87], s15 offen offset:0 sc1
    v_mfma_f32_32x32x16_bf16 v[80:95], v[188:191], v[128:131], v[80:95]
    buffer_load_dwordx4 v[116:119], v6, s[84:87], s15 offen offset:0 sc1
    v_mfma_f32_32x32x16_bf16 v[64:79], v[184:187], v[132:135], v[64:79]
    v_mfma_f32_32x32x16_bf16 v[96:111], v[188:191], v[132:135], v[96:111]
    s_waitcnt vmcnt(8)
    v_mfma_f32_32x32x16_bf16 v[48:63], v[192:195], v[40:43], v[48:63]
    buffer_load_dwordx4 v[152:155], v9, s[84:87], s15 offen offset:1024 sc1
    v_mfma_f32_32x32x16_bf16 v[80:95], v[196:199], v[40:43], v[80:95]
    buffer_load_dwordx4 v[156:159], v6, s[84:87], s15 offen offset:1024 sc1
    v_mfma_f32_32x32x16_bf16 v[64:79], v[192:195], v[44:47], v[64:79]
    v_mfma_f32_32x32x16_bf16 v[96:111], v[196:199], v[44:47], v[96:111]
    s_waitcnt vmcnt(8)
    v_mfma_f32_32x32x16_bf16 v[48:63], v[200:203], v[136:139], v[48:63]
    s_add_u32 s15, s36, 2
    s_and_b32 s15, s15, 3
    s_lshl_b32 s15, s15, 12
    s_add_u32 s15, s15, s90
    buffer_load_dwordx4 v[24:27], v9, s[84:87], s15 offen offset:0 sc1
    v_mfma_f32_32x32x16_bf16 v[80:95], v[204:207], v[136:139], v[80:95]
    buffer_load_dwordx4 v[28:31], v6, s[84:87], s15 offen offset:0 sc1
    v_mfma_f32_32x32x16_bf16 v[64:79], v[200:203], v[140:143], v[64:79]
    v_mfma_f32_32x32x16_bf16 v[96:111], v[204:207], v[140:143], v[96:111]
    s_add_u32 s39, s39, 256
    s_mov_b32 s101, 0
    s_atomic_add s101, s[84:85], s39 glc
    s_waitcnt vmcnt(8)
    v_mfma_f32_32x32x16_bf16 v[48:63], v[208:211], v[16:19], v[48:63]
    buffer_load_dwordx4 v[160:163], v9, s[84:87], s15 offen offset:1024 sc1
    v_mfma_f32_32x32x16_bf16 v[80:95], v[212:215], v[16:19], v[80:95]
    buffer_load_dwordx4 v[164:167], v6, s[84:87], s15 offen offset:1024 sc1
    v_mfma_f32_32x32x16_bf16 v[64:79], v[208:211], v[20:23], v[64:79]
    v_mfma_f32_32x32x16_bf16 v[96:111], v[212:215], v[20:23], v[96:111]
    s_waitcnt vmcnt(8)
    v_mfma_f32_32x32x16_bf16 v[48:63], v[216:219], v[144:147], v[48:63]
    s_add_u32 s15, s36, 3
    s_and_b32 s15, s15, 3
    s_lshl_b32 s15, s15, 12
    s_add_u32 s15, s15, s90
    buffer_load_dwordx4 v[120:123], v9, s[84:87], s15 offen offset:0 sc1
    v_mfma_f32_32x32x16_bf16 v[80:95], v[220:223], v[144:147], v[80:95]
    buffer_load_dwordx4 v[124:127], v6, s[84:87], s15 offen offset:0 sc1
    v_mfma_f32_32x32x16_bf16 v[64:79], v[216:219], v[148:151], v[64:79]
    v_mfma_f32_32x32x16_bf16 v[96:111], v[220:223], v[148:151], v[96:111]
    s_add_u32 s13, s36, 3
    s_and_b32 s13, s13, 3
    s_lshl_b32 s13, s13, 13
    s_add_u32 s13, s13, s96
    s_add_u32 s13, s13, 4096
    buffer_load_dwordx4 v[168:171], v10, s[84:87], s13 offen offset:0 sc1
    buffer_load_dwordx4 v[172:175], v0, s[84:87], s13 offen offset:1024 sc1
    s_waitcnt vmcnt(10)
    v_mfma_f32_32x32x16_bf16 v[48:63], v[224:227], v[112:115], v[48:63]
    buffer_load_dwordx4 v[32:35], v9, s[84:87], s15 offen offset:1024 sc1
    v_mfma_f32_32x32x16_bf16 v[80:95], v[228:231], v[112:115], v[80:95]
    buffer_load_dwordx4 v[36:39], v6, s[84:87], s15 offen offset:1024 sc1
    v_mfma_f32_32x32x16_bf16 v[64:79], v[224:227], v[116:119], v[64:79]
    v_mfma_f32_32x32x16_bf16 v[96:111], v[228:231], v[116:119], v[96:111]
    s_add_u32 s13, s36, 3
    s_and_b32 s13, s13, 3
    s_lshl_b32 s13, s13, 13
    s_add_u32 s13, s13, s96
    s_add_u32 s13, s13, 4096
    buffer_load_dwordx4 v[176:179], v10, s[84:87], s13 offen offset:2048 sc1
    buffer_load_dwordx4 v[180:183], v0, s[84:87], s13 offen offset:3072 sc1
    s_waitcnt lgkmcnt(0)
    s_cmp_lt_u32 s101, 8
    s_cbranch_scc0 L_if_80
    s_mov_b32 s98, 0
L_poll_81:
    s_mov_b32 s99, 0
    s_atomic_add s99, s[84:85], s39 glc
    s_add_u32 s98, s98, 1
    s_waitcnt lgkmcnt(0)
    s_cmp_ge_u32 s99, 8
    s_cbranch_scc1 L_pdone_82
    s_sleep 2
    s_cmp_lt_u32 s98, 0x100000
    s_cbranch_scc1 L_poll_81
L_pdone_82:
L_if_80:
    s_waitcnt vmcnt(12)
    v_mfma_f32_32x32x16_bf16 v[48:63], v[232:235], v[152:155], v[48:63]
    s_add_u32 s15, s36, 0
    s_and_b32 s15, s15, 3
    s_lshl_b32 s15, s15, 12
    s_add_u32 s15, s15, s90
    s_add_u32 s15, s15, 2048
    buffer_load_dwordx4 v[128:131], v9, s[84:87], s15 offen offset:0 sc1
    v_mfma_f32_32x32x16_bf16 v[80:95], v[236:239], v[152:155], v[80:95]
    buffer_load_dwordx4 v[132:135], v6, s[84:87], s15 offen offset:0 sc1
    v_mfma_f32_32x32x16_bf16 v[64:79], v[232:235], v[156:159], v[64:79]
    v_mfma_f32_32x32x16_bf16 v[96:111], v[236:239], v[156:159], v[96:111]
    ds_read_b128 v[184:187], v14 offset:8192
    ds_read_b128 v[188:191], v14 offset:9216
    s_waitcnt vmcnt(12)
    v_mfma_f32_32x32x16_bf16 v[48:63], v[240:243], v[24:27], v[48:63]
    buffer_load_dwordx4 v[40:43], v9, s[84:87], s15 offen offset:1024 sc1
    v_mfma_f32_32x32x16_bf16 v[80:95], v[244:247], v[24:27], v[80:95]
    buffer_load_dwordx4 v[44:47], v6, s[84:87], s15 offen offset:1024 sc1
    v_mfma_f32_32x32x16_bf16 v[64:79], v[240:243], v[28:31], v[64:79]
    v_mfma_f32_32x32x16_bf16 v[96:111], v[244:247], v[28:31], v[96:111]
    ds_read_b128 v[192:195], v14 offset:10240
    ds_read_b128 v[196:199], v14 offset:11264
    s_waitcnt vmcnt(12)
    v_mfma_f32_32x32x16_bf16 v[48:63], v[248:251], v[160:163], v[48:63]
    s_add_u32 s15, s36, 1
    s_and_b32 s15, s15, 3
    s_lshl_b32 s15, s15, 12
    s_add_u32 s15, s15, s90
    s_add_u32 s15, s15, 2048
    buffer_load_dwordx4 v[136:139], v9, s[84:87], s15 offen offset:0 sc1
    v_mfma_f32_32x32x16_bf16 v[80:95], v[252:255], v[160:163], v[80:95]
    buffer_load_dwordx4 v[140:143], v6, s[84:87], s15 offen offset:0 sc1
    v_mfma_f32_32x32x16_bf16 v[64:79], v[248:251], v[164:167], v[64:79]
    v_mfma_f32_32x32x16_bf16 v[96:111], v[252:255], v[164:167], v[96:111]
    ds_read_b128 v[200:203], v14 offset:40960
    ds_read_b128 v[204:207], v14 offset:41984
    s_waitcnt vmcnt(12) lgkmcnt(4)
    v_mfma_f32_32x32x16_bf16 v[48:63], v[184:187], v[120:123], v[48:63]
    buffer_load_dwordx4 v[16:19], v9, s[84:87], s15 offen offset:1024 sc1
    v_mfma_f32_32x32x16_bf16 v[80:95], v[188:191], v[120:123], v[80:95]
    buffer_load_dwordx4 v[20:23], v6, s[84:87], s15 offen offset:1024 sc1
    v_mfma_f32_32x32x16_bf16 v[64:79], v[184:187], v[124:127], v[64:79]
    v_mfma_f32_32x32x16_bf16 v[96:111], v[188:191], v[124:127], v[96:111]
    ds_read_b128 v[208:211], v14 offset:43008
    ds_read_b128 v[212:215], v14 offset:44032
    s_waitcnt vmcnt(10) lgkmcnt(4)
    v_mfma_f32_32x32x16_bf16 v[48:63], v[192:195], v[32:35], v[48:63]
    s_add_u32 s15, s36, 2
    s_and_b32 s15, s15, 3
    s_lshl_b32 s15, s15, 12
    s_add_u32 s15, s15, s90
    s_add_u32 s15, s15, 2048
    buffer_load_dwordx4 v[144:147], v9, s[84:87], s15 offen offset:0 sc1
    v_mfma_f32_32x32x16_bf16 v[80:95], v[196:199], v[32:35], v[80:95]
    buffer_load_dwordx4 v[148:151], v6, s[84:87], s15 offen offset:0 sc1
    v_mfma_f32_32x32x16_bf16 v[64:79], v[192:195], v[36:39], v[64:79]
    v_mfma_f32_32x32x16_bf16 v[96:111], v[196:199], v[36:39], v[96:111]
    ds_read_b128 v[216:219], v13 offset:0
    ds_read_b128 v[220:223], v13 offset:1024
    s_waitcnt vmcnt(8) lgkmcnt(4)
    v_mfma_f32_32x32x16_bf16 v[48:63], v[200:203], v[128:131], v[48:63]
    buffer_load_dwordx4 v[112:115], v9, s[84:87], s15 offen offset:1024 sc1
    v_mfma_f32_32x32x16_bf16 v[80:95], v[204:207], v[128:131], v[80:95]
    buffer_load_dwordx4 v[116:119], v6, s[84:87], s15 offen offset:1024 sc1
    v_mfma_f32_32x32x16_bf16 v[64:79], v[200:203], v[132:135], v[64:79]
    v_mfma_f32_32x32x16_bf16 v[96:111], v[204:207], v[132:135], v[96:111]
    ds_read_b128 v[224:227], v13 offset:2048
    ds_read_b128 v[228:231], v13 offset:3072
    s_waitcnt vmcnt(8) lgkmcnt(4)
    v_mfma_f32_32x32x16_bf16 v[48:63], v[208:211], v[40:43], v[48:63]
    s_add_u32 s15, s36, 3
    s_and_b32 s15, s15, 3
    s_lshl_b32 s15, s15, 12
    s_add_u32 s15, s15, s90
    s_add_u32 s15, s15, 2048
    buffer_load_dwordx4 v[152:155], v9, s[84:87], s15 offen offset:0 sc1
    v_mfma_f32_32x32x16_bf16 v[80:95], v[212:215], v[40:43], v[80:95]
    buffer_load_dwordx4 v[156:159], v6, s[84:87], s15 offen offset:0 sc1
    v_mfma_f32_32x32x16_bf16 v[64:79], v[208:211], v[44:47], v[64:79]
    v_mfma_f32_32x32x16_bf16 v[96:111], v[212:215], v[44:47], v[96:111]
    ds_read_b128 v[232:235], v13 offset:16384
    ds_read_b128 v[236:239], v13 offset:17408
    s_waitcnt vmcnt(8) lgkmcnt(4)
    v_mfma_f32_32x32x16_bf16 v[48:63], v[216:219], v[136:139], v[48:63]
    buffer_load_dwordx4 v[24:27], v9, s[84:87], s15 offen offset:1024 sc1
    v_mfma_f32_32x32x16_bf16 v[80:95], v[220:223], v[136:139], v[80:95]
    buffer_load_dwordx4 v[28:31], v6, s[84:87], s15 offen offset:1024 sc1
    v_mfma_f32_32x32x16_bf16 v[64:79], v[216:219], v[140:143], v[64:79]
    v_mfma_f32_32x32x16_bf16 v[96:111], v[220:223], v[140:143], v[96:111]
    ds_read_b128 v[240:243], v13 offset:18432
    ds_read_b128 v[244:247], v13 offset:19456
    s_waitcnt vmcnt(8) lgkmcnt(4)
    v_mfma_f32_32x32x16_bf16 v[48:63], v[224:227], v[16:19], v[48:63]
    v_mfma_f32_32x32x16_bf16 v[80:95], v[228:231], v[16:19], v[80:95]
    v_mfma_f32_32x32x16_bf16 v[64:79], v[224:227], v[20:23], v[64:79]
    v_mfma_f32_32x32x16_bf16 v[96:111], v[228:231], v[20:23], v[96:111]
    s_waitcnt vmcnt(6) lgkmcnt(2)
    v_mfma_f32_32x32x16_bf16 v[48:63], v[232:235], v[144:147], v[48:63]
    v_mfma_f32_32x32x16_bf16 v[80:95], v[236:239], v[144:147], v[80:95]
    v_mfma_f32_32x32x16_bf16 v[64:79], v[232:235], v[148:151], v[64:79]
    v_mfma_f32_32x32x16_bf16 v[96:111], v[236:239], v[148:151], v[96:111]
    s_waitcnt vmcnt(4) lgkmcnt(0)
    v_mfma_f32_32x32x16_bf16 v[48:63], v[240:243], v[112:115], v[48:63]
    v_mfma_f32_32x32x16_bf16 v[80:95], v[244:247], v[112:115], v[80:95]
    v_mfma_f32_32x32x16_bf16 v[64:79], v[240:243], v[116:119], v[64:79]
    v_mfma_f32_32x32x16_bf16 v[96:111], v[244:247], v[116:119], v[96:111]
    s_xor_b32 s13, s3, 1
    s_lshl_b32 s13, s13, 12
    s_add_u32 s13, s13, 73728
    v_add_u32 v10, s13, v7
    s_xor_b32 s13, s3, 2
    s_lshl_b32 s13, s13, 12
    s_add_u32 s13, s13, 106496
    v_add_u32 v11, s13, v7
    s_xor_b32 s13, s3, 3
    s_lshl_b32 s13, s13, 12
    s_add_u32 s13, s13, 0
    v_add_u32 v12, s13, v7
    s_and_b32 s13, s3, 1
    s_lshl_b32 s13, s13, 12
    s_lshr_b32 s14, s3, 1
    s_lshl_b32 s14, s14, 11
    s_add_u32 s13, s13, s14
    s_add_u32 s13, s13, 90112
    v_add_u32 v3, s13, v7
    ds_read_b128 v[160:163], v3 offset:0
    ds_read_b128 v[164:167], v3 offset:1024
    s_waitcnt vmcnt(0)
    v_mfma_f32_32x32x16_bf16 v[64:79], v[168:171], v[156:159], v[64:79]
    v_mfma_f32_32x32x16_bf16 v[64:79], v[176:179], v[28:31], v[64:79]
    v_mfma_f32_32x32x16_bf16 v[80:95], v[172:175], v[152:155], v[80:95]
    v_mfma_f32_32x32x16_bf16 v[80:95], v[180:183], v[24:27], v[80:95]
    v_mfma_f32_32x32x16_bf16 v[96:111], v[172:175], v[156:159], v[96:111]
    v_mfma_f32_32x32x16_bf16 v[96:111], v[180:183], v[28:31], v[96:111]
    s_nop 7
    ds_write_b128 v14, v[64:67] offset:8192
    ds_write_b128 v14, v[68:71] offset:9216
    ds_write_b128 v14, v[72:75] offset:10240
    ds_write_b128 v14, v[76:79] offset:11264
    v_mfma_f32_32x32x16_bf16 v[48:63], v[168:171], v[152:155], v[48:63]
    v_mfma_f32_32x32x16_bf16 v[48:63], v[176:179], v[24:27], v[48:63]
    ds_write_b128 v14, v[80:83] offset:40960
    ds_write_b128 v14, v[84:87] offset:41984
    ds_write_b128 v14, v[88:91] offset:43008
    ds_write_b128 v14, v[92:95] offset:44032
    ds_write_b128 v13, v[96:99] offset:0
    ds_write_b128 v13, v[100:103] offset:1024
    ds_write_b128 v13, v[104:107] offset:2048
    ds_write_b128 v13, v[108:111] offset:3072
    s_lshl_b32 s13, s6, 1
    s_add_u32 s13, s13, s8
    s_lshl_b32 s13, s13, 1
    s_and_b32 s14, s3, 1
    s_add_u32 s13, s13, s14
    s_lshl_b32 s13, s13, 15
    s_lshl_b32 s14, s9, 7
    s_add_u32 s13, s13, s14
    s_lshr_b32 s14, s3, 1
    s_lshl_b32 s14, s14, 6
    s_add_u32 s13, s13, s14
    v_and_b32 v4, 31, v1
    v_lshlrev_b32 v4, 10, v4
    v_lshrrev_b32 v5, 5, v1
    v_lshl_add_u32 v4, v5, 4, v4
    s_waitcnt lgkmcnt(12)
    v_lshlrev_b32 v176, 16, v160
    v_and_b32 v177, s93, v160
    v_lshlrev_b32 v178, 16, v161
    v_and_b32 v179, s93, v161
    v_lshlrev_b32 v180, 16, v162
    v_and_b32 v181, s93, v162
    v_lshlrev_b32 v182, 16, v163
    v_and_b32 v183, s93, v163
    v_lshlrev_b32 v184, 16, v164
    v_and_b32 v185, s93, v164
    v_lshlrev_b32 v186, 16, v165
    v_and_b32 v187, s93, v165
    v_lshlrev_b32 v188, 16, v166
    v_and_b32 v189, s93, v166
    v_lshlrev_b32 v190, 16, v167
    v_and_b32 v191, s93, v167
    s_waitcnt lgkmcnt(0)
    s_barrier
    ds_read_b128 v[112:115], v10 offset:0
    ds_read_b128 v[116:119], v10 offset:1024
    ds_read_b128 v[120:123], v10 offset:2048
    ds_read_b128 v[124:127], v10 offset:3072
    ds_read_b128 v[128:131], v11 offset:0
    ds_read_b128 v[132:135], v11 offset:1024
    ds_read_b128 v[136:139], v11 offset:2048
    ds_read_b128 v[140:143], v11 offset:3072
    ds_read_b128 v[144:147], v12 offset:0
    ds_read_b128 v[148:151], v12 offset:1024
    ds_read_b128 v[152:155], v12 offset:2048
    ds_read_b128 v[156:159], v12 offset:3072
    s_waitcnt lgkmcnt(8)
    v_pk_add_f32 v[48:49], v[48:49], v[112:113]
    v_pk_add_f32 v[50:51], v[50:51], v[114:115]
    v_pk_add_f32 v[52:53], v[52:53], v[116:117]
    v_pk_add_f32 v[54:55], v[54:55], v[118:119]
    v_pk_add_f32 v[56:57], v[56:57], v[120:121]
    v_pk_add_f32 v[58:59], v[58:59], v[122:123]
    v_pk_add_f32 v[60:61], v[60:61], v[124:125]
    v_pk_add_f32 v[62:63], v[62:63], v[126:127]
    s_waitcnt lgkmcnt(4)
    v_pk_add_f32 v[48:49], v[48:49], v[128:129]
    v_pk_add_f32 v[50:51], v[50:51], v[130:131]
    v_pk_add_f32 v[52:53], v[52:53], v[132:133]
    v_pk_add_f32 v[54:55], v[54:55], v[134:135]
    v_pk_add_f32 v[56:57], v[56:57], v[136:137]
    v_pk_add_f32 v[58:59], v[58:59], v[138:139]
    v_pk_add_f32 v[60:61], v[60:61], v[140:141]
    v_pk_add_f32 v[62:63], v[62:63], v[142:143]
    s_waitcnt lgkmcnt(0)
    v_pk_add_f32 v[48:49], v[48:49], v[144:145]
    v_pk_add_f32 v[50:51], v[50:51], v[146:147]
    v_pk_add_f32 v[52:53], v[52:53], v[148:149]
    v_pk_add_f32 v[54:55], v[54:55], v[150:151]
    v_pk_add_f32 v[56:57], v[56:57], v[152:153]
    v_pk_add_f32 v[58:59], v[58:59], v[154:155]
    v_pk_add_f32 v[60:61], v[60:61], v[156:157]
    v_pk_add_f32 v[62:63], v[62:63], v[158:159]
    v_permlane32_swap_b32 v48, v52
    v_permlane32_swap_b32 v49, v53
    v_permlane32_swap_b32 v50, v54
    v_permlane32_swap_b32 v51, v55
    v_permlane32_swap_b32 v56, v60
    v_permlane32_swap_b32 v57, v61
    v_permlane32_swap_b32 v58, v62
    v_permlane32_swap_b32 v59, v63
    v_pk_add_f32 v[48:49], v[48:49], v[176:177]
    v_pk_add_f32 v[50:51], v[50:51], v[178:179]
    v_pk_add_f32 v[52:53], v[52:53], v[180:181]
    v_pk_add_f32 v[54:55], v[54:55], v[182:183]
    v_pk_add_f32 v[56:57], v[56:57], v[184:185]
    v_pk_add_f32 v[58:59], v[58:59], v[186:187]
    v_pk_add_f32 v[60:61], v[60:61], v[188:189]
    v_pk_add_f32 v[62:63], v[62:63], v[190:191]
    v_cvt_pk_bf16_f32 v64, v48, v49
    v_cvt_pk_bf16_f32 v65, v50, v51
    v_cvt_pk_bf16_f32 v66, v52, v53
    v_cvt_pk_bf16_f32 v67, v54, v55
    v_cvt_pk_bf16_f32 v68, v56, v57
    v_cvt_pk_bf16_f32 v69, v58, v59
    v_cvt_pk_bf16_f32 v70, v60, v61
    v_cvt_pk_bf16_f32 v71, v62, v63
    buffer_store_dwordx4 v[64:67], v4, s[76:79], s13 offen offset:0
    buffer_store_dwordx4 v[68:71], v4, s[76:79], s13 offen offset:32
    s_endpgm
L_end:
    s_endpgm
.set CODE_SPAN, L_end - sequential_preLN__ssm_conv_h3__swiglu_ffn__prompt_kernel - 256

.section .rodata,"a"
.p2align 6
.amdhsa_kernel sequential_preLN__ssm_conv_h3__swiglu_ffn__prompt_kernel
  .amdhsa_next_free_vgpr 256
  .amdhsa_next_free_sgpr 102
  .amdhsa_accum_offset 256
  .amdhsa_group_segment_fixed_size 0
  .amdhsa_kernarg_size 104
  .amdhsa_user_sgpr_count 2
  .amdhsa_user_sgpr_kernarg_segment_ptr 1
  .amdhsa_system_sgpr_workgroup_id_x 1
.end_amdhsa_kernel
```
